```python
import torch

def _softmax(x, axis=-1):
    return torch.softmax(x, dim=axis)
def _gelu(x):
    return torch.nn.functional.gelu(x, approximate="tanh")
def _silu(x):
    return torch.nn.functional.silu(x)
def _sigmoid(x):
    return torch.sigmoid(x)
def _layernorm(x, axis=-1, eps=1e-5):
    m = x.mean(dim=axis, keepdim=True)
    v = x.var(dim=axis, keepdim=True, unbiased=False)
    return (x - m) / torch.sqrt(v + eps)
def _scatter_add(tgt, idx, src, axis=0):
    return tgt.clone().index_add_(axis, idx, src)
def _segment_sum(src, seg, n):
    out = torch.zeros((n,) + src.shape[1:], dtype=src.dtype)
    return out.index_add_(0, seg, src)
def _pad(x, pw):
    flat = tuple(v for pair in reversed(pw) for v in pair)
    return torch.nn.functional.pad(x, flat)

kernel_name = 'sequential_preLN__spectral_fnet__glu_gated_glu__prompt'

def setup_inputs():

    _w = (lambda a: (lambda t: t.to(torch.bfloat16) if t.is_floating_point() else t)(torch.as_tensor(a)))
    def _A_setup():
        B, S, D = 1, 2048, 512
        ns = torch.arange(S)[:, None] * torch.arange(S)[None, :]
        nd = torch.arange(D)[:, None] * torch.arange(D)[None, :]
        Ws_re = torch.cos(-2.0 * torch.pi * ns / S).to(float)
        Ws_im = torch.sin(-2.0 * torch.pi * ns / S).to(float)
        Wd_re = torch.cos(-2.0 * torch.pi * nd / D).to(float)
        Wd_im = torch.sin(-2.0 * torch.pi * nd / D).to(float)
        return {
            "x": _w((lambda *s: torch.randn(*s, dtype=torch.bfloat16) * 0.05)(B, S, D)),
            "dft_seq_re": _w(Ws_re),
            "dft_seq_im": _w(Ws_im),
            "dft_hid_re": _w(Wd_re),
            "dft_hid_im": _w(Wd_im),
        }
    _A_in = _A_setup()

    def _B_setup():
        B, S, D, F = 1, 2048, 512, 1792
        return {
            "x": _w((lambda *s: torch.randn(*s, dtype=torch.bfloat16) * 0.05)(B, S, D)),
            "w_gate": _w((lambda *s: torch.randn(*s, dtype=torch.bfloat16) * 1.6)(D, F)),
            "w_up": _w((lambda *s: torch.randn(*s, dtype=torch.bfloat16) * 0.8)(D, F)),
            "w_down": _w((lambda *s: torch.randn(*s, dtype=torch.bfloat16) * 0.8)(F, D)),
        }
    _B_in = _B_setup()

    return {
        "A_x": _A_in["x"],
        "A_dft_seq_re": _A_in["dft_seq_re"],
        "A_dft_seq_im": _A_in["dft_seq_im"],
        "A_dft_hid_re": _A_in["dft_hid_re"],
        "A_dft_hid_im": _A_in["dft_hid_im"],
        "B_x": _B_in["x"],
        "B_w_gate": _B_in["w_gate"],
        "B_w_up": _B_in["w_up"],
        "B_w_down": _B_in["w_down"],
    }

def reference(A_x, A_dft_seq_re, A_dft_seq_im, A_dft_hid_re, A_dft_hid_im, B_x, B_w_gate, B_w_up, B_w_down):
    def _A_ref(x, dft_seq_re, dft_seq_im, dft_hid_re, dft_hid_im):
        a = torch.einsum("bsd,ed->bse", x, dft_hid_re)
        b = torch.einsum("bsd,ed->bse", x, dft_hid_im)
        y = torch.einsum("ts,bse->bte", dft_seq_re, a) - torch.einsum("ts,bse->bte", dft_seq_im, b)
        return y

    def _B_ref(x, w_gate, w_up, w_down):
        g = torch.einsum("bsd,df->bsf", x, w_gate)
        u = torch.einsum("bsd,df->bsf", x, w_up)
        h = _sigmoid(g) * u
        return torch.einsum("bsf,fd->bsd", h, w_down)

    x = A_x
    h = x + _A_ref(_layernorm(x, axis=-1), A_dft_seq_re, A_dft_seq_im, A_dft_hid_re, A_dft_hid_im)
    h2 = h + _B_ref(_layernorm(h, axis=-1), B_w_gate, B_w_up, B_w_down)
    return h2
```

```asm
; @launch kernel=k1_kernel grid=(424,1,1) block=(256,1,1) lds=32768
; @launch kernel=k3_kernel grid=(256,1,1) block=(512,1,1) lds=163840
.amdgcn_target "amdgcn-amd-amdhsa--gfx950"
.text
.globl k1_kernel
.p2align 8
.type k1_kernel,@function
k1_kernel:
    s_cmp_ge_u32 s2, 424
    s_cbranch_scc1 .L_k1_end
    s_load_dwordx2 s[12:13], s[0:1], 88
    v_and_b32 v1, 63, v0
    v_lshrrev_b32 v2, 6, v0
    s_nop 0
    v_readfirstlane_b32 s14, v2
    s_cmp_ge_u32 s2, 368
    s_cbranch_scc1 .L_k1_pd
    s_cmp_ge_u32 s2, 256
    s_cbranch_scc1 .L_k1_pg
    s_load_dwordx2 s[4:5], s[0:1], 0
    s_lshr_b32 s15, s2, 5
    s_bfe_u32 s16, s2, 0x30002
    s_lshl_b32 s16, s16, 3
    s_add_u32 s15, s15, s16
    s_and_b32 s16, s2, 3
    s_lshl_b32 s17, s16, 3
    s_lshl_b32 s18, s14, 1
    s_add_u32 s17, s17, s18
    s_lshl_b32 s17, s17, 6
    s_add_u32 s17, s17, s15
    s_lshl_b32 s17, s17, 10
    v_lshlrev_b32 v3, 4, v1
    v_add_u32 v4, s17, v3
    v_add_u32 v5, 0x10000, v4
    s_waitcnt lgkmcnt(0)
    global_load_dwordx4 v[8:11], v4, s[4:5]
    global_load_dwordx4 v[12:15], v5, s[4:5]
    s_getpc_b64 s[40:41]
.pc_k1_kernel_1:
    s_add_u32 s40, s40, k3_kernel-.pc_k1_kernel_1
    s_addc_u32 s41, s41, 0
    v_lshlrev_b32 v128, 6, v0
    v_min_u32 v129, code_end_marker-k3_kernel-4, v128
    global_load_dword v130, v129, s[40:41]
    v_add_u32 v128, 0x4000, v128
    v_min_u32 v129, code_end_marker-k3_kernel-4, v128
    global_load_dword v131, v129, s[40:41]
    s_cmp_ge_u32 s2, 2
    s_cbranch_scc1 .zc_k1_kernel_2
    s_lshl_b32 s44, s2, 16
    s_add_u32 s44, s44, 18874368
    v_lshlrev_b32 v132, 8, v0
    v_add_u32 v132, s44, v132
    v_mov_b32 v133, 0
    global_store_dword v132, v133, s[12:13]
    s_waitcnt vmcnt(0)
.zc_k1_kernel_2:
    s_cmp_lg_u32 s14, 0
    s_cbranch_scc1 .tw_k1_kernel_3
    s_load_dwordx2 s[46:47], s[0:1], 72
    v_min_u32 v132, 9, v1
    v_lshlrev_b32 v132, 21, v132
    global_load_dword v133, v132, s[12:13]
    v_and_b32 v132, 1, v1
    v_lshlrev_b32 v132, 20, v132
    s_waitcnt lgkmcnt(0)
    global_load_dword v134, v132, s[46:47]
    s_waitcnt vmcnt(0)
.tw_k1_kernel_3:
    v_bfe_u32 v6, v1, 1, 4
    v_and_b32 v7, 1, v1
    v_lshrrev_b32 v2, 5, v1
    v_cvt_f32_u32 v64, v6
    v_cvt_f32_u32 v65, v7
    v_cvt_f32_u32 v66, v2
    v_fma_f32 v60, v65, -2.0, 1.0
    v_mul_f32 v67, 0x3d800000, v64
    v_mul_f32 v68, 0x41000000, v66
    v_mul_f32 v68, v68, v67
    v_fmac_f32 v68, 0x3e800000, v65
    v_cos_f32 v72, v68
    v_add_f32 v68, v68, v67
    v_cos_f32 v73, v68
    v_add_f32 v68, v68, v67
    v_cos_f32 v74, v68
    v_add_f32 v68, v68, v67
    v_cos_f32 v75, v68
    v_add_f32 v68, v68, v67
    v_cos_f32 v76, v68
    v_add_f32 v68, v68, v67
    v_cos_f32 v77, v68
    v_add_f32 v68, v68, v67
    v_cos_f32 v78, v68
    v_add_f32 v68, v68, v67
    v_cos_f32 v79, v68
    s_nop 0
    v_cvt_pk_bf16_f32 v16, v72, v73
    v_cvt_pk_bf16_f32 v17, v74, v75
    v_cvt_pk_bf16_f32 v18, v76, v77
    v_cvt_pk_bf16_f32 v19, v78, v79
    v_mul_f32 v67, 0x3b000000, v64
    v_mul_f32 v69, v67, v60
    v_mul_f32 v70, 0x40a00000, v67
    v_mul_f32 v71, 0x40a00000, v69
    v_mul_f32 v68, 4.0, v66
    v_mul_f32 v72, v68, v67
    v_mul_f32 v73, v68, v69
    v_cos_f32 v28, v72
    v_sin_f32 v44, v73
    v_add_f32 v72, v72, v67
    v_add_f32 v73, v73, v69
    v_cos_f32 v29, v72
    v_sin_f32 v45, v73
    v_add_f32 v72, v72, v67
    v_add_f32 v73, v73, v69
    v_cos_f32 v30, v72
    v_sin_f32 v46, v73
    v_add_f32 v72, v72, v67
    v_add_f32 v73, v73, v69
    v_cos_f32 v31, v72
    v_sin_f32 v47, v73
    v_add_f32 v72, v72, v70
    v_add_f32 v73, v73, v71
    v_cos_f32 v32, v72
    v_sin_f32 v48, v73
    v_add_f32 v72, v72, v67
    v_add_f32 v73, v73, v69
    v_cos_f32 v33, v72
    v_sin_f32 v49, v73
    v_add_f32 v72, v72, v67
    v_add_f32 v73, v73, v69
    v_cos_f32 v34, v72
    v_sin_f32 v50, v73
    v_add_f32 v72, v72, v67
    v_add_f32 v73, v73, v69
    v_cos_f32 v35, v72
    v_sin_f32 v51, v73
    v_add_f32 v72, v72, v70
    v_add_f32 v73, v73, v71
    v_cos_f32 v36, v72
    v_sin_f32 v52, v73
    v_add_f32 v72, v72, v67
    v_add_f32 v73, v73, v69
    v_cos_f32 v37, v72
    v_sin_f32 v53, v73
    v_add_f32 v72, v72, v67
    v_add_f32 v73, v73, v69
    v_cos_f32 v38, v72
    v_sin_f32 v54, v73
    v_add_f32 v72, v72, v67
    v_add_f32 v73, v73, v69
    v_cos_f32 v39, v72
    v_sin_f32 v55, v73
    v_add_f32 v72, v72, v70
    v_add_f32 v73, v73, v71
    v_cos_f32 v40, v72
    v_sin_f32 v56, v73
    v_add_f32 v72, v72, v67
    v_add_f32 v73, v73, v69
    v_cos_f32 v41, v72
    v_sin_f32 v57, v73
    v_add_f32 v72, v72, v67
    v_add_f32 v73, v73, v69
    v_cos_f32 v42, v72
    v_sin_f32 v58, v73
    v_add_f32 v72, v72, v67
    v_add_f32 v73, v73, v69
    v_cos_f32 v43, v72
    v_sin_f32 v59, v73
    v_and_b32 v6, 15, v1
    v_bfe_u32 v7, v1, 4, 1
    v_cvt_f32_u32 v64, v6
    v_cvt_f32_u32 v65, v7
    v_mul_f32 v67, 0x3d000000, v64
    v_mul_f32 v70, 0x40a00000, v67
    v_mul_f32 v72, v68, v67
    v_fmac_f32 v72, 0xbe800000, v65
    v_cos_f32 v74, v72
    v_add_f32 v72, v72, v67
    v_cos_f32 v75, v72
    v_add_f32 v72, v72, v67
    v_cvt_pk_bf16_f32 v20, v74, v75
    v_cos_f32 v74, v72
    v_add_f32 v72, v72, v67
    v_cos_f32 v75, v72
    v_add_f32 v72, v72, v70
    v_cvt_pk_bf16_f32 v21, v74, v75
    v_cos_f32 v74, v72
    v_add_f32 v72, v72, v67
    v_cos_f32 v75, v72
    v_add_f32 v72, v72, v67
    v_cvt_pk_bf16_f32 v22, v74, v75
    v_cos_f32 v74, v72
    v_add_f32 v72, v72, v67
    v_cos_f32 v75, v72
    v_add_f32 v72, v72, v70
    v_cvt_pk_bf16_f32 v23, v74, v75
    v_cos_f32 v74, v72
    v_add_f32 v72, v72, v67
    v_cos_f32 v75, v72
    v_add_f32 v72, v72, v67
    v_cvt_pk_bf16_f32 v24, v74, v75
    v_cos_f32 v74, v72
    v_add_f32 v72, v72, v67
    v_cos_f32 v75, v72
    v_add_f32 v72, v72, v70
    v_cvt_pk_bf16_f32 v25, v74, v75
    v_cos_f32 v74, v72
    v_add_f32 v72, v72, v67
    v_cos_f32 v75, v72
    v_add_f32 v72, v72, v67
    v_cvt_pk_bf16_f32 v26, v74, v75
    v_cos_f32 v74, v72
    v_add_f32 v72, v72, v67
    v_cos_f32 v75, v72
    s_nop 0
    v_cvt_pk_bf16_f32 v27, v74, v75
    s_lshl_b32 s18, s14, 11
    s_add_u32 s18, s18, 0
    v_add_u32 v4, s18, v3
    v_lshlrev_b32 v5, 9, v2
    v_bfe_u32 v6, v1, 2, 2
    v_lshl_add_u32 v5, v6, 6, v5
    v_bfe_u32 v6, v1, 4, 1
    v_lshl_add_u32 v5, v6, 5, v5
    v_and_b32 v6, 3, v1
    v_lshl_add_u32 v5, v6, 3, v5
    v_add_u32 v5, s18, v5
    s_mov_b32 s30, 0xffff0000
    s_waitcnt vmcnt(3)
    ds_write_b128 v4, v[8:11] offset:0
    s_waitcnt vmcnt(2)
    ds_write_b128 v4, v[12:15] offset:1024
    s_waitcnt lgkmcnt(1)
    ds_read_b64_tr_b16 v[96:97], v5 offset:0
    ds_read_b64_tr_b16 v[98:99], v5 offset:256
    s_waitcnt lgkmcnt(2)
    ds_read_b64_tr_b16 v[100:101], v5 offset:1024
    ds_read_b64_tr_b16 v[102:103], v5 offset:1280
    v_lshlrev_b32 v112, 16, v8
    v_and_b32 v113, s30, v8
    v_lshlrev_b32 v114, 16, v9
    v_and_b32 v115, s30, v9
    v_lshlrev_b32 v116, 16, v10
    v_and_b32 v117, s30, v10
    v_lshlrev_b32 v118, 16, v11
    v_and_b32 v119, s30, v11
    v_add_f32 v104, v112, v114
    v_add_f32 v105, v113, v115
    v_mul_f32 v106, v112, v112
    v_mul_f32 v107, v113, v113
    v_add_f32 v104, v104, v116
    v_add_f32 v105, v105, v117
    v_add_f32 v104, v104, v118
    v_add_f32 v105, v105, v119
    v_fmac_f32 v106, v114, v114
    v_fmac_f32 v107, v115, v115
    v_fmac_f32 v106, v116, v116
    v_fmac_f32 v107, v117, v117
    v_fmac_f32 v106, v118, v118
    v_fmac_f32 v107, v119, v119
    v_add_f32 v106, v106, v107
    s_waitcnt lgkmcnt(2)
    v_mfma_f32_32x32x16_bf16 v[64:79], v[96:99], v[16:19], 0
    v_lshlrev_b32 v112, 16, v12
    v_and_b32 v113, s30, v12
    v_lshlrev_b32 v114, 16, v13
    v_and_b32 v115, s30, v13
    v_lshlrev_b32 v116, 16, v14
    v_and_b32 v117, s30, v14
    v_lshlrev_b32 v118, 16, v15
    v_and_b32 v119, s30, v15
    v_add_f32 v108, v112, v114
    v_add_f32 v109, v113, v115
    v_mul_f32 v110, v112, v112
    v_mul_f32 v111, v113, v113
    v_add_f32 v108, v108, v116
    v_add_f32 v109, v109, v117
    v_add_f32 v108, v108, v118
    v_add_f32 v109, v109, v119
    v_fmac_f32 v110, v114, v114
    v_fmac_f32 v111, v115, v115
    v_fmac_f32 v110, v116, v116
    v_fmac_f32 v111, v117, v117
    v_fmac_f32 v110, v118, v118
    v_fmac_f32 v111, v119, v119
    v_add_f32 v110, v110, v111
    s_waitcnt lgkmcnt(0)
    v_mfma_f32_32x32x16_bf16 v[80:95], v[100:103], v[16:19], 0
    v_add_f32_dpp v104, v104, v104 row_shr:1 row_mask:0xf bank_mask:0xf bound_ctrl:0
    v_add_f32_dpp v105, v105, v105 row_shr:1 row_mask:0xf bank_mask:0xf bound_ctrl:0
    v_add_f32_dpp v106, v106, v106 row_shr:1 row_mask:0xf bank_mask:0xf bound_ctrl:0
    v_add_f32_dpp v108, v108, v108 row_shr:1 row_mask:0xf bank_mask:0xf bound_ctrl:0
    v_add_f32_dpp v109, v109, v109 row_shr:1 row_mask:0xf bank_mask:0xf bound_ctrl:0
    v_add_f32_dpp v110, v110, v110 row_shr:1 row_mask:0xf bank_mask:0xf bound_ctrl:0
    v_add_f32_dpp v104, v104, v104 row_shr:2 row_mask:0xf bank_mask:0xf bound_ctrl:0
    v_add_f32_dpp v105, v105, v105 row_shr:2 row_mask:0xf bank_mask:0xf bound_ctrl:0
    v_add_f32_dpp v106, v106, v106 row_shr:2 row_mask:0xf bank_mask:0xf bound_ctrl:0
    v_add_f32_dpp v108, v108, v108 row_shr:2 row_mask:0xf bank_mask:0xf bound_ctrl:0
    v_add_f32_dpp v109, v109, v109 row_shr:2 row_mask:0xf bank_mask:0xf bound_ctrl:0
    v_add_f32_dpp v110, v110, v110 row_shr:2 row_mask:0xf bank_mask:0xf bound_ctrl:0
    v_add_f32_dpp v104, v104, v104 row_shr:4 row_mask:0xf bank_mask:0xf bound_ctrl:0
    v_add_f32_dpp v105, v105, v105 row_shr:4 row_mask:0xf bank_mask:0xf bound_ctrl:0
    v_add_f32_dpp v106, v106, v106 row_shr:4 row_mask:0xf bank_mask:0xf bound_ctrl:0
    v_add_f32_dpp v108, v108, v108 row_shr:4 row_mask:0xf bank_mask:0xf bound_ctrl:0
    v_add_f32_dpp v109, v109, v109 row_shr:4 row_mask:0xf bank_mask:0xf bound_ctrl:0
    v_add_f32_dpp v110, v110, v110 row_shr:4 row_mask:0xf bank_mask:0xf bound_ctrl:0
    v_add_f32_dpp v104, v104, v104 row_shr:8 row_mask:0xf bank_mask:0xf bound_ctrl:0
    v_add_f32_dpp v105, v105, v105 row_shr:8 row_mask:0xf bank_mask:0xf bound_ctrl:0
    v_add_f32_dpp v106, v106, v106 row_shr:8 row_mask:0xf bank_mask:0xf bound_ctrl:0
    v_add_f32_dpp v108, v108, v108 row_shr:8 row_mask:0xf bank_mask:0xf bound_ctrl:0
    v_add_f32_dpp v109, v109, v109 row_shr:8 row_mask:0xf bank_mask:0xf bound_ctrl:0
    v_add_f32_dpp v110, v110, v110 row_shr:8 row_mask:0xf bank_mask:0xf bound_ctrl:0
    v_add_f32_dpp v104, v104, v104 row_bcast:15 row_mask:0xa bank_mask:0xf
    v_add_f32_dpp v105, v105, v105 row_bcast:15 row_mask:0xa bank_mask:0xf
    v_add_f32_dpp v106, v106, v106 row_bcast:15 row_mask:0xa bank_mask:0xf
    v_add_f32_dpp v108, v108, v108 row_bcast:15 row_mask:0xa bank_mask:0xf
    v_add_f32_dpp v109, v109, v109 row_bcast:15 row_mask:0xa bank_mask:0xf
    v_add_f32_dpp v110, v110, v110 row_bcast:15 row_mask:0xa bank_mask:0xf
    v_add_f32_dpp v104, v104, v104 row_bcast:31 row_mask:0xc bank_mask:0xf
    v_add_f32_dpp v105, v105, v105 row_bcast:31 row_mask:0xc bank_mask:0xf
    v_add_f32_dpp v106, v106, v106 row_bcast:31 row_mask:0xc bank_mask:0xf
    v_add_f32_dpp v108, v108, v108 row_bcast:31 row_mask:0xc bank_mask:0xf
    v_add_f32_dpp v109, v109, v109 row_bcast:31 row_mask:0xc bank_mask:0xf
    v_add_f32_dpp v110, v110, v110 row_bcast:31 row_mask:0xc bank_mask:0xf
    s_nop 0
    v_readlane_b32 s32, v104, 63
    v_readlane_b32 s33, v105, 63
    v_readlane_b32 s34, v106, 63
    v_readlane_b32 s35, v108, 63
    v_readlane_b32 s36, v109, 63
    v_readlane_b32 s37, v110, 63
    v_mul_f32 v112, v28, v64
    v_mul_f32 v113, v29, v65
    v_mul_f32 v114, v30, v66
    v_mul_f32 v115, v31, v67
    v_mul_f32 v116, v32, v68
    v_mul_f32 v117, v33, v69
    v_mul_f32 v118, v34, v70
    v_mul_f32 v119, v35, v71
    v_mul_f32 v120, v36, v72
    v_mul_f32 v121, v37, v73
    v_mul_f32 v122, v38, v74
    v_mul_f32 v123, v39, v75
    v_mul_f32 v124, v40, v76
    v_mul_f32 v125, v41, v77
    v_mul_f32 v126, v42, v78
    v_mul_f32 v127, v43, v79
    v_fmac_f32_dpp v112, v64, v44 quad_perm:[1,0,3,2] row_mask:0xf bank_mask:0xf
    v_fmac_f32_dpp v113, v65, v45 quad_perm:[1,0,3,2] row_mask:0xf bank_mask:0xf
    v_fmac_f32_dpp v114, v66, v46 quad_perm:[1,0,3,2] row_mask:0xf bank_mask:0xf
    v_fmac_f32_dpp v115, v67, v47 quad_perm:[1,0,3,2] row_mask:0xf bank_mask:0xf
    v_fmac_f32_dpp v116, v68, v48 quad_perm:[1,0,3,2] row_mask:0xf bank_mask:0xf
    v_fmac_f32_dpp v117, v69, v49 quad_perm:[1,0,3,2] row_mask:0xf bank_mask:0xf
    v_fmac_f32_dpp v118, v70, v50 quad_perm:[1,0,3,2] row_mask:0xf bank_mask:0xf
    v_fmac_f32_dpp v119, v71, v51 quad_perm:[1,0,3,2] row_mask:0xf bank_mask:0xf
    v_fmac_f32_dpp v120, v72, v52 quad_perm:[1,0,3,2] row_mask:0xf bank_mask:0xf
    v_fmac_f32_dpp v121, v73, v53 quad_perm:[1,0,3,2] row_mask:0xf bank_mask:0xf
    v_fmac_f32_dpp v122, v74, v54 quad_perm:[1,0,3,2] row_mask:0xf bank_mask:0xf
    v_fmac_f32_dpp v123, v75, v55 quad_perm:[1,0,3,2] row_mask:0xf bank_mask:0xf
    v_fmac_f32_dpp v124, v76, v56 quad_perm:[1,0,3,2] row_mask:0xf bank_mask:0xf
    v_fmac_f32_dpp v125, v77, v57 quad_perm:[1,0,3,2] row_mask:0xf bank_mask:0xf
    v_fmac_f32_dpp v126, v78, v58 quad_perm:[1,0,3,2] row_mask:0xf bank_mask:0xf
    v_fmac_f32_dpp v127, v79, v59 quad_perm:[1,0,3,2] row_mask:0xf bank_mask:0xf
    v_cvt_pk_bf16_f32 v96, v112, v113
    v_cvt_pk_bf16_f32 v97, v114, v115
    v_cvt_pk_bf16_f32 v98, v116, v117
    v_cvt_pk_bf16_f32 v99, v118, v119
    v_cvt_pk_bf16_f32 v100, v120, v121
    v_cvt_pk_bf16_f32 v101, v122, v123
    v_cvt_pk_bf16_f32 v102, v124, v125
    v_cvt_pk_bf16_f32 v103, v126, v127
    s_nop 1
    v_mfma_f32_32x32x16_bf16 v[64:79], v[20:23], v[96:99], 0
    v_mfma_f32_32x32x16_bf16 v[64:79], v[24:27], v[100:103], v[64:79]
    v_mul_f32 v112, v28, v80
    v_mul_f32 v113, v29, v81
    v_mul_f32 v114, v30, v82
    v_mul_f32 v115, v31, v83
    v_mul_f32 v116, v32, v84
    v_mul_f32 v117, v33, v85
    v_mul_f32 v118, v34, v86
    v_mul_f32 v119, v35, v87
    v_mul_f32 v120, v36, v88
    v_mul_f32 v121, v37, v89
    v_mul_f32 v122, v38, v90
    v_mul_f32 v123, v39, v91
    v_mul_f32 v124, v40, v92
    v_mul_f32 v125, v41, v93
    v_mul_f32 v126, v42, v94
    v_mul_f32 v127, v43, v95
    v_fmac_f32_dpp v112, v80, v44 quad_perm:[1,0,3,2] row_mask:0xf bank_mask:0xf
    v_fmac_f32_dpp v113, v81, v45 quad_perm:[1,0,3,2] row_mask:0xf bank_mask:0xf
    v_fmac_f32_dpp v114, v82, v46 quad_perm:[1,0,3,2] row_mask:0xf bank_mask:0xf
    v_fmac_f32_dpp v115, v83, v47 quad_perm:[1,0,3,2] row_mask:0xf bank_mask:0xf
    v_fmac_f32_dpp v116, v84, v48 quad_perm:[1,0,3,2] row_mask:0xf bank_mask:0xf
    v_fmac_f32_dpp v117, v85, v49 quad_perm:[1,0,3,2] row_mask:0xf bank_mask:0xf
    v_fmac_f32_dpp v118, v86, v50 quad_perm:[1,0,3,2] row_mask:0xf bank_mask:0xf
    v_fmac_f32_dpp v119, v87, v51 quad_perm:[1,0,3,2] row_mask:0xf bank_mask:0xf
    v_fmac_f32_dpp v120, v88, v52 quad_perm:[1,0,3,2] row_mask:0xf bank_mask:0xf
    v_fmac_f32_dpp v121, v89, v53 quad_perm:[1,0,3,2] row_mask:0xf bank_mask:0xf
    v_fmac_f32_dpp v122, v90, v54 quad_perm:[1,0,3,2] row_mask:0xf bank_mask:0xf
    v_fmac_f32_dpp v123, v91, v55 quad_perm:[1,0,3,2] row_mask:0xf bank_mask:0xf
    v_fmac_f32_dpp v124, v92, v56 quad_perm:[1,0,3,2] row_mask:0xf bank_mask:0xf
    v_fmac_f32_dpp v125, v93, v57 quad_perm:[1,0,3,2] row_mask:0xf bank_mask:0xf
    v_fmac_f32_dpp v126, v94, v58 quad_perm:[1,0,3,2] row_mask:0xf bank_mask:0xf
    v_fmac_f32_dpp v127, v95, v59 quad_perm:[1,0,3,2] row_mask:0xf bank_mask:0xf
    v_cvt_pk_bf16_f32 v104, v112, v113
    v_cvt_pk_bf16_f32 v105, v114, v115
    v_cvt_pk_bf16_f32 v106, v116, v117
    v_cvt_pk_bf16_f32 v107, v118, v119
    v_cvt_pk_bf16_f32 v108, v120, v121
    v_cvt_pk_bf16_f32 v109, v122, v123
    v_cvt_pk_bf16_f32 v110, v124, v125
    v_cvt_pk_bf16_f32 v111, v126, v127
    s_nop 1
    v_mfma_f32_32x32x16_bf16 v[80:95], v[20:23], v[104:107], 0
    v_mfma_f32_32x32x16_bf16 v[80:95], v[24:27], v[108:111], v[80:95]
    v_mov_b32 v12, s32
    v_add_f32 v13, s33, v12
    v_subrev_f32 v14, s33, v12
    v_mul_f32 v13, 0x3b000000, v13
    v_mov_b32 v15, s34
    v_mul_f32 v15, 0x3b000000, v15
    v_fma_f32 v15, -v13, v13, v15
    v_max_f32 v15, 0, v15
    v_add_f32 v15, 0x3727c5ac, v15
    v_rsq_f32 v8, v15
    v_max_f32 v12, 0, v60
    v_mul_f32 v14, v14, v12
    v_mul_f32 v10, v14, v8
    v_mov_b32 v12, s35
    v_add_f32 v13, s36, v12
    v_subrev_f32 v14, s36, v12
    v_mul_f32 v13, 0x3b000000, v13
    v_mov_b32 v15, s37
    v_mul_f32 v15, 0x3b000000, v15
    v_fma_f32 v15, -v13, v13, v15
    v_max_f32 v15, 0, v15
    v_add_f32 v15, 0x3727c5ac, v15
    v_rsq_f32 v9, v15
    v_max_f32 v12, 0, v60
    v_mul_f32 v14, v14, v12
    v_mul_f32 v11, v14, v9
    v_cmp_gt_u32 vcc, 2, v1
    s_lshl_b32 s18, s14, 2
    s_add_u32 s18, s18, 8192
    v_add_u32 v4, s18, v3
    v_fmac_f32_dpp v64, v72, v60 quad_perm:[1,0,3,2] row_mask:0xf bank_mask:0xf
    v_fmac_f32_dpp v65, v73, v60 quad_perm:[1,0,3,2] row_mask:0xf bank_mask:0xf
    v_fmac_f32_dpp v66, v74, v60 quad_perm:[1,0,3,2] row_mask:0xf bank_mask:0xf
    v_fmac_f32_dpp v67, v75, v60 quad_perm:[1,0,3,2] row_mask:0xf bank_mask:0xf
    v_fmac_f32_dpp v68, v76, v60 quad_perm:[1,0,3,2] row_mask:0xf bank_mask:0xf
    v_fmac_f32_dpp v69, v77, v60 quad_perm:[1,0,3,2] row_mask:0xf bank_mask:0xf
    v_fmac_f32_dpp v70, v78, v60 quad_perm:[1,0,3,2] row_mask:0xf bank_mask:0xf
    v_fmac_f32_dpp v71, v79, v60 quad_perm:[1,0,3,2] row_mask:0xf bank_mask:0xf
    v_mul_f32 v64, v64, v8
    v_mul_f32 v65, v65, v8
    v_mul_f32 v66, v66, v8
    v_mul_f32 v67, v67, v8
    v_mul_f32 v68, v68, v8
    v_mul_f32 v69, v69, v8
    v_mul_f32 v70, v70, v8
    v_mul_f32 v71, v71, v8
    v_cndmask_b32 v64, v64, v10, vcc
    v_fmac_f32_dpp v80, v88, v60 quad_perm:[1,0,3,2] row_mask:0xf bank_mask:0xf
    v_fmac_f32_dpp v81, v89, v60 quad_perm:[1,0,3,2] row_mask:0xf bank_mask:0xf
    v_fmac_f32_dpp v82, v90, v60 quad_perm:[1,0,3,2] row_mask:0xf bank_mask:0xf
    v_fmac_f32_dpp v83, v91, v60 quad_perm:[1,0,3,2] row_mask:0xf bank_mask:0xf
    v_fmac_f32_dpp v84, v92, v60 quad_perm:[1,0,3,2] row_mask:0xf bank_mask:0xf
    v_fmac_f32_dpp v85, v93, v60 quad_perm:[1,0,3,2] row_mask:0xf bank_mask:0xf
    v_fmac_f32_dpp v86, v94, v60 quad_perm:[1,0,3,2] row_mask:0xf bank_mask:0xf
    v_fmac_f32_dpp v87, v95, v60 quad_perm:[1,0,3,2] row_mask:0xf bank_mask:0xf
    v_mul_f32 v80, v80, v9
    v_mul_f32 v81, v81, v9
    v_mul_f32 v82, v82, v9
    v_mul_f32 v83, v83, v9
    v_mul_f32 v84, v84, v9
    v_mul_f32 v85, v85, v9
    v_mul_f32 v86, v86, v9
    v_mul_f32 v87, v87, v9
    v_cndmask_b32 v80, v80, v11, vcc
    v_cvt_pk_bf16_f32 v112, v64, v80
    ds_write_b32 v4, v112 offset:0
    v_cvt_pk_bf16_f32 v113, v65, v81
    ds_write_b32 v4, v113 offset:1024
    v_cvt_pk_bf16_f32 v114, v66, v82
    ds_write_b32 v4, v114 offset:2048
    v_cvt_pk_bf16_f32 v115, v67, v83
    ds_write_b32 v4, v115 offset:3072
    v_cvt_pk_bf16_f32 v116, v68, v84
    ds_write_b32 v4, v116 offset:4096
    v_cvt_pk_bf16_f32 v117, v69, v85
    ds_write_b32 v4, v117 offset:5120
    v_cvt_pk_bf16_f32 v118, v70, v86
    ds_write_b32 v4, v118 offset:6144
    v_cvt_pk_bf16_f32 v119, v71, v87
    ds_write_b32 v4, v119 offset:7168
    v_bfe_u32 v6, v1, 1, 4
    v_lshl_add_u32 v6, v2, 6, v6
    s_lshl_b32 s18, s14, 4
    s_sub_u32 s18, s18, 1
    v_add_u32 v6, s18, v6
    v_add_u32 v7, 128, v6
    v_and_b32 v6, 255, v6
    s_lshr_b32 s18, s15, 4
    s_lshl_b32 s18, s18, 13
    s_lshl_b32 s19, s16, 8
    s_add_u32 s18, s18, s19
    s_and_b32 s19, s15, 15
    s_lshl_b32 s19, s19, 4
    s_add_u32 s18, s18, s19
    v_and_b32 v12, 1, v1
    v_lshlrev_b32 v12, 10, v12
    v_add_u32 v12, s18, v12
    v_lshrrev_b32 v13, 2, v6
    v_lshl_add_u32 v13, v13, 15, v12
    v_and_b32 v14, 3, v6
    v_lshl_add_u32 v6, v14, 11, v13
    v_lshrrev_b32 v13, 2, v7
    v_lshl_add_u32 v13, v13, 15, v12
    v_and_b32 v14, 3, v7
    v_lshl_add_u32 v7, v14, 11, v13
    v_lshlrev_b32 v5, 4, v0
    v_add_u32 v5, 0, v5
    v_and_b32 v12, 7, v0
    v_lshrrev_b32 v13, 3, v0
    v_lshlrev_b32 v8, 10, v12
    v_add_u32 v8, 0, v8
    v_lshl_add_u32 v8, v13, 3, v8
    v_add_u32 v9, 8, v8
    v_add_u32 v10, 264, v8
    v_lshlrev_b32 v14, 10, v12
    v_add_u32 v14, 0, v14
    v_cmp_eq_u32 vcc, 31, v13
    v_lshlrev_b32 v11, 3, v13
    v_sub_u32 v11, 760, v11
    v_add_u32 v11, v11, v14
    v_cndmask_b32 v10, v10, v14, vcc
    s_lshl_b32 s18, s15, 15
    s_lshl_b32 s19, s16, 7
    s_add_u32 s18, s18, s19
    s_add_u32 s18, s18, 2097152
    v_lshlrev_b32 v15, 9, v13
    v_lshl_add_u32 v15, v12, 4, v15
    v_add_u32 v15, s18, v15
    v_add_u32 v14, 0x4000, v15
    s_waitcnt lgkmcnt(0)
    s_barrier
    ds_read_b128 v[16:19], v5 offset:8192
    ds_read_b128 v[20:23], v5 offset:12288
    ds_read_b64 v[24:25], v8 offset:0
    ds_read_b32 v26, v9
    ds_read_b64 v[30:31], v11 offset:256
    ds_read_b64 v[32:33], v8 offset:256
    ds_read_b32 v34, v10
    ds_read_b64 v[38:39], v11 offset:0
    s_waitcnt lgkmcnt(7)
    global_store_dwordx4 v6, v[16:19], s[12:13]
    s_waitcnt lgkmcnt(6)
    global_store_dwordx4 v7, v[20:23], s[12:13]
    s_waitcnt lgkmcnt(3)
    v_alignbit_b32 v28, v25, v24, 16
    v_alignbit_b32 v29, v26, v25, 16
    global_store_dwordx4 v15, v[28:31], s[12:13] offset:0 sc1
    s_waitcnt lgkmcnt(0)
    v_alignbit_b32 v36, v33, v32, 16
    v_alignbit_b32 v37, v34, v33, 16
    global_store_dwordx4 v14, v[36:39], s[12:13] sc1
    s_endpgm
.L_k1_pg:
    s_sub_u32 s15, s2, 256
    s_load_dwordx4 s[4:7], s[0:1], 48
    s_mul_i32 s16, s15, 9363
    s_lshr_b32 s16, s16, 16
    s_mul_i32 s17, s16, 7
    s_sub_u32 s17, s15, s17
    s_lshr_b32 s18, s14, 1
    s_and_b32 s19, s14, 1
    v_lshrrev_b32 v2, 5, v1
    v_and_b32 v3, 31, v1
    v_lshlrev_b32 v3, 4, v3
    s_lshl_b32 s20, s17, 9
    v_add_u32 v3, s20, v3
    s_lshl_b32 s21, s16, 2
    s_lshl_b32 s22, s19, 1
    s_add_u32 s21, s21, s22
    s_lshl_b32 s21, s21, 2
    s_movk_i32 s23, 3584
    s_add_u32 s24, s21, 1
    v_add_u32 v4, s24, v2
    v_and_b32 v4, 255, v4
    v_mad_u32_u24 v8, v4, s23, v3
    s_add_u32 s24, s21, 3
    v_add_u32 v4, s24, v2
    v_and_b32 v4, 255, v4
    v_mad_u32_u24 v9, v4, s23, v3
    s_sub_u32 s24, 508, s21
    v_add_u32 v4, s24, v2
    v_mad_u32_u24 v10, v4, s23, v3
    s_sub_u32 s24, 510, s21
    v_add_u32 v4, s24, v2
    v_mad_u32_u24 v11, v4, s23, v3
    s_add_u32 s24, s21, 5
    v_add_u32 v4, s24, v2
    v_and_b32 v4, 255, v4
    v_mad_u32_u24 v12, v4, s23, v3
    s_add_u32 s24, s21, 7
    v_add_u32 v4, s24, v2
    v_and_b32 v4, 255, v4
    v_mad_u32_u24 v13, v4, s23, v3
    s_sub_u32 s24, 504, s21
    v_add_u32 v4, s24, v2
    v_mad_u32_u24 v14, v4, s23, v3
    s_sub_u32 s24, 506, s21
    v_add_u32 v4, s24, v2
    v_mad_u32_u24 v15, v4, s23, v3
    s_lshl_b32 s25, s14, 13
    s_add_u32 s25, s25, 0
    s_waitcnt lgkmcnt(0)
    s_cmp_eq_u32 s18, 0
    s_cselect_b32 s4, s4, s6
    s_cselect_b32 s5, s5, s7
    s_add_u32 m0, s25, 0
    s_nop 0
    global_load_lds_dwordx4 v8, s[4:5]
    s_add_u32 m0, s25, 1024
    s_nop 0
    global_load_lds_dwordx4 v9, s[4:5]
    s_add_u32 m0, s25, 2048
    s_nop 0
    global_load_lds_dwordx4 v10, s[4:5]
    s_add_u32 m0, s25, 3072
    s_nop 0
    global_load_lds_dwordx4 v11, s[4:5]
    s_add_u32 m0, s25, 4096
    s_nop 0
    global_load_lds_dwordx4 v12, s[4:5]
    s_add_u32 m0, s25, 5120
    s_nop 0
    global_load_lds_dwordx4 v13, s[4:5]
    s_add_u32 m0, s25, 6144
    s_nop 0
    global_load_lds_dwordx4 v14, s[4:5]
    s_add_u32 m0, s25, 7168
    s_nop 0
    global_load_lds_dwordx4 v15, s[4:5]
    v_bfe_u32 v4, v1, 4, 1
    v_lshlrev_b32 v4, 14, v4
    v_lshl_add_u32 v4, v2, 12, v4
    v_bfe_u32 v5, v1, 2, 2
    v_lshl_add_u32 v4, v5, 9, v4
    v_and_b32 v5, 3, v1
    v_lshl_add_u32 v4, v5, 3, v4
    s_lshl_b32 s24, s14, 7
    s_add_u32 s24, s24, 0
    v_add_u32 v4, s24, v4
    v_lshlrev_b32 v6, 4, v1
    s_mov_b32 s30, 1065369472
    s_waitcnt vmcnt(0)
    s_barrier
    ds_read_b64_tr_b16 v[16:17], v4 offset:0
    ds_read_b64_tr_b16 v[18:19], v4 offset:2048
    ds_read_b64_tr_b16 v[20:21], v4 offset:8192
    ds_read_b64_tr_b16 v[22:23], v4 offset:10240
    ds_read_b64_tr_b16 v[24:25], v4 offset:32
    ds_read_b64_tr_b16 v[26:27], v4 offset:2080
    ds_read_b64_tr_b16 v[28:29], v4 offset:8224
    ds_read_b64_tr_b16 v[30:31], v4 offset:10272
    ds_read_b64_tr_b16 v[32:33], v4 offset:64
    ds_read_b64_tr_b16 v[34:35], v4 offset:2112
    ds_read_b64_tr_b16 v[36:37], v4 offset:8256
    ds_read_b64_tr_b16 v[38:39], v4 offset:10304
    ds_read_b64_tr_b16 v[40:41], v4 offset:96
    ds_read_b64_tr_b16 v[42:43], v4 offset:2144
    ds_read_b64_tr_b16 v[44:45], v4 offset:8288
    ds_read_b64_tr_b16 v[46:47], v4 offset:10336
    s_lshl_b32 s24, s17, 4
    s_lshl_b32 s26, s14, 2
    s_add_u32 s24, s24, s26
    s_add_u32 s24, s24, 0
    s_mul_i32 s26, s24, 9363
    s_lshr_b32 s26, s26, 16
    s_mul_i32 s27, s26, 7
    s_sub_u32 s27, s24, s27
    s_lshl_b32 s26, s26, 5
    s_lshl_b32 s28, s16, 1
    s_add_u32 s26, s26, s28
    s_mul_i32 s26, s26, 7
    s_add_u32 s26, s26, s27
    s_lshl_b32 s26, s26, 10
    s_add_u32 s26, s26, 4194304
    s_add_u32 s8, s12, s26
    s_addc_u32 s9, s13, 0
    s_add_u32 s10, s8, 7168
    s_addc_u32 s11, s9, 0
    s_waitcnt lgkmcnt(12)
    global_store_dwordx4 v6, v[16:19], s[8:9] sc1
    global_store_dwordx4 v6, v[20:23], s[10:11] sc1
    v_mov_b32 v48, 0
    v_dot2_f32_bf16 v48, v16, s30, v48
    v_dot2_f32_bf16 v48, v17, s30, v48
    v_dot2_f32_bf16 v48, v18, s30, v48
    v_dot2_f32_bf16 v48, v19, s30, v48
    v_dot2_f32_bf16 v48, v20, s30, v48
    v_dot2_f32_bf16 v48, v21, s30, v48
    v_dot2_f32_bf16 v48, v22, s30, v48
    v_dot2_f32_bf16 v48, v23, s30, v48
    s_lshl_b32 s24, s17, 4
    s_lshl_b32 s26, s14, 2
    s_add_u32 s24, s24, s26
    s_add_u32 s24, s24, 1
    s_mul_i32 s26, s24, 9363
    s_lshr_b32 s26, s26, 16
    s_mul_i32 s27, s26, 7
    s_sub_u32 s27, s24, s27
    s_lshl_b32 s26, s26, 5
    s_lshl_b32 s28, s16, 1
    s_add_u32 s26, s26, s28
    s_mul_i32 s26, s26, 7
    s_add_u32 s26, s26, s27
    s_lshl_b32 s26, s26, 10
    s_add_u32 s26, s26, 4194304
    s_add_u32 s8, s12, s26
    s_addc_u32 s9, s13, 0
    s_add_u32 s10, s8, 7168
    s_addc_u32 s11, s9, 0
    s_waitcnt lgkmcnt(8)
    global_store_dwordx4 v6, v[24:27], s[8:9] sc1
    global_store_dwordx4 v6, v[28:31], s[10:11] sc1
    v_mov_b32 v49, 0
    v_dot2_f32_bf16 v49, v24, s30, v49
    v_dot2_f32_bf16 v49, v25, s30, v49
    v_dot2_f32_bf16 v49, v26, s30, v49
    v_dot2_f32_bf16 v49, v27, s30, v49
    v_dot2_f32_bf16 v49, v28, s30, v49
    v_dot2_f32_bf16 v49, v29, s30, v49
    v_dot2_f32_bf16 v49, v30, s30, v49
    v_dot2_f32_bf16 v49, v31, s30, v49
    s_lshl_b32 s24, s17, 4
    s_lshl_b32 s26, s14, 2
    s_add_u32 s24, s24, s26
    s_add_u32 s24, s24, 2
    s_mul_i32 s26, s24, 9363
    s_lshr_b32 s26, s26, 16
    s_mul_i32 s27, s26, 7
    s_sub_u32 s27, s24, s27
    s_lshl_b32 s26, s26, 5
    s_lshl_b32 s28, s16, 1
    s_add_u32 s26, s26, s28
    s_mul_i32 s26, s26, 7
    s_add_u32 s26, s26, s27
    s_lshl_b32 s26, s26, 10
    s_add_u32 s26, s26, 4194304
    s_add_u32 s8, s12, s26
    s_addc_u32 s9, s13, 0
    s_add_u32 s10, s8, 7168
    s_addc_u32 s11, s9, 0
    s_waitcnt lgkmcnt(4)
    global_store_dwordx4 v6, v[32:35], s[8:9] sc1
    global_store_dwordx4 v6, v[36:39], s[10:11] sc1
    v_mov_b32 v50, 0
    v_dot2_f32_bf16 v50, v32, s30, v50
    v_dot2_f32_bf16 v50, v33, s30, v50
    v_dot2_f32_bf16 v50, v34, s30, v50
    v_dot2_f32_bf16 v50, v35, s30, v50
    v_dot2_f32_bf16 v50, v36, s30, v50
    v_dot2_f32_bf16 v50, v37, s30, v50
    v_dot2_f32_bf16 v50, v38, s30, v50
    v_dot2_f32_bf16 v50, v39, s30, v50
    s_lshl_b32 s24, s17, 4
    s_lshl_b32 s26, s14, 2
    s_add_u32 s24, s24, s26
    s_add_u32 s24, s24, 3
    s_mul_i32 s26, s24, 9363
    s_lshr_b32 s26, s26, 16
    s_mul_i32 s27, s26, 7
    s_sub_u32 s27, s24, s27
    s_lshl_b32 s26, s26, 5
    s_lshl_b32 s28, s16, 1
    s_add_u32 s26, s26, s28
    s_mul_i32 s26, s26, 7
    s_add_u32 s26, s26, s27
    s_lshl_b32 s26, s26, 10
    s_add_u32 s26, s26, 4194304
    s_add_u32 s8, s12, s26
    s_addc_u32 s9, s13, 0
    s_add_u32 s10, s8, 7168
    s_addc_u32 s11, s9, 0
    s_waitcnt lgkmcnt(0)
    global_store_dwordx4 v6, v[40:43], s[8:9] sc1
    global_store_dwordx4 v6, v[44:47], s[10:11] sc1
    v_mov_b32 v51, 0
    v_dot2_f32_bf16 v51, v40, s30, v51
    v_dot2_f32_bf16 v51, v41, s30, v51
    v_dot2_f32_bf16 v51, v42, s30, v51
    v_dot2_f32_bf16 v51, v43, s30, v51
    v_dot2_f32_bf16 v51, v44, s30, v51
    v_dot2_f32_bf16 v51, v45, s30, v51
    v_dot2_f32_bf16 v51, v46, s30, v51
    v_dot2_f32_bf16 v51, v47, s30, v51
    s_nop 2
    v_mov_b32 v52, v48
    v_mov_b32 v53, v49
    v_mov_b32 v54, v50
    v_mov_b32 v55, v51
    s_nop 0
    v_permlane32_swap_b32 v52, v48
    v_permlane32_swap_b32 v53, v49
    v_permlane32_swap_b32 v54, v50
    v_permlane32_swap_b32 v55, v51
    s_nop 0
    v_add_f32 v48, v48, v52
    v_add_f32 v49, v49, v53
    v_add_f32 v50, v50, v54
    v_add_f32 v51, v51, v55
    v_cmp_gt_u32 vcc, 32, v1
    s_nop 1
    v_cndmask_b32 v52, v50, v48, vcc
    v_cndmask_b32 v53, v51, v49, vcc
    s_mul_i32 s24, s16, 112
    s_lshl_b32 s26, s17, 4
    s_add_u32 s24, s24, s26
    s_lshl_b32 s26, s14, 2
    s_add_u32 s24, s24, s26
    s_lshl_b32 s24, s24, 7
    s_add_u32 s24, s24, 7864320
    v_and_b32 v5, 31, v1
    v_lshlrev_b32 v5, 2, v5
    v_lshl_add_u32 v5, v2, 8, v5
    v_add_u32 v5, s24, v5
    global_store_dword v5, v52, s[12:13] sc1
    global_store_dword v5, v53, s[12:13] offset:128 sc1
    s_endpgm
.L_k1_pd:
    s_sub_u32 s15, s2, 368
    s_load_dwordx2 s[4:5], s[0:1], 64
    s_lshl_b32 s16, s15, 15
    s_lshl_b32 s25, s14, 13
    s_add_u32 s16, s16, s25
    s_add_u32 s25, s25, 0
    v_lshlrev_b32 v6, 4, v1
    v_add_u32 v3, s16, v6
    v_add_u32 v7, 4096, v3
    s_waitcnt lgkmcnt(0)
    s_add_u32 m0, s25, 0
    s_nop 0
    global_load_lds_dwordx4 v3, s[4:5] offset:0
    s_add_u32 m0, s25, 0
    s_nop 0
    global_load_lds_dwordx4 v3, s[4:5] offset:1024
    s_add_u32 m0, s25, 0
    s_nop 0
    global_load_lds_dwordx4 v3, s[4:5] offset:2048
    s_add_u32 m0, s25, 0
    s_nop 0
    global_load_lds_dwordx4 v3, s[4:5] offset:3072
    s_add_u32 m0, s25, 4096
    s_nop 0
    global_load_lds_dwordx4 v7, s[4:5] offset:0
    s_add_u32 m0, s25, 4096
    s_nop 0
    global_load_lds_dwordx4 v7, s[4:5] offset:1024
    s_add_u32 m0, s25, 4096
    s_nop 0
    global_load_lds_dwordx4 v7, s[4:5] offset:2048
    s_add_u32 m0, s25, 4096
    s_nop 0
    global_load_lds_dwordx4 v7, s[4:5] offset:3072
    v_lshrrev_b32 v2, 5, v1
    v_lshlrev_b32 v4, 12, v2
    v_bfe_u32 v5, v1, 2, 2
    v_lshl_add_u32 v4, v5, 10, v4
    v_bfe_u32 v5, v1, 4, 1
    v_lshl_add_u32 v4, v5, 4, v4
    v_and_b32 v5, 1, v1
    v_lshl_add_u32 v4, v5, 5, v4
    v_bfe_u32 v5, v1, 1, 1
    v_lshl_add_u32 v4, v5, 3, v4
    s_lshl_b32 s24, s14, 8
    s_add_u32 s24, s24, 0
    v_add_u32 v4, s24, v4
    s_waitcnt vmcnt(0)
    s_barrier
    ds_read_b64_tr_b16 v[16:17], v4 offset:0
    ds_read_b64_tr_b16 v[18:19], v4 offset:8192
    ds_read_b64_tr_b16 v[20:21], v4 offset:64
    ds_read_b64_tr_b16 v[22:23], v4 offset:8256
    ds_read_b64_tr_b16 v[24:25], v4 offset:16384
    ds_read_b64_tr_b16 v[26:27], v4 offset:24576
    ds_read_b64_tr_b16 v[28:29], v4 offset:16448
    ds_read_b64_tr_b16 v[30:31], v4 offset:24640
    ds_read_b64_tr_b16 v[32:33], v4 offset:128
    ds_read_b64_tr_b16 v[34:35], v4 offset:8320
    ds_read_b64_tr_b16 v[36:37], v4 offset:192
    ds_read_b64_tr_b16 v[38:39], v4 offset:8384
    ds_read_b64_tr_b16 v[40:41], v4 offset:16512
    ds_read_b64_tr_b16 v[42:43], v4 offset:24704
    ds_read_b64_tr_b16 v[44:45], v4 offset:16576
    ds_read_b64_tr_b16 v[46:47], v4 offset:24768
    s_lshl_b32 s24, s14, 1
    s_add_u32 s24, s24, 0
    s_mul_i32 s24, s24, 112
    s_lshl_b32 s26, s15, 1
    s_add_u32 s24, s24, s26
    s_lshl_b32 s24, s24, 11
    s_add_u32 s24, s24, 8388608
    s_add_u32 s8, s12, s24
    s_addc_u32 s9, s13, 0
    s_waitcnt lgkmcnt(8)
    global_store_dwordx4 v6, v[16:19], s[8:9] offset:0 sc1
    global_store_dwordx4 v6, v[20:23], s[8:9] offset:1024 sc1
    global_store_dwordx4 v6, v[24:27], s[8:9] offset:2048 sc1
    global_store_dwordx4 v6, v[28:31], s[8:9] offset:3072 sc1
    s_lshl_b32 s24, s14, 1
    s_add_u32 s24, s24, 1
    s_mul_i32 s24, s24, 112
    s_lshl_b32 s26, s15, 1
    s_add_u32 s24, s24, s26
    s_lshl_b32 s24, s24, 11
    s_add_u32 s24, s24, 8388608
    s_add_u32 s8, s12, s24
    s_addc_u32 s9, s13, 0
    s_waitcnt lgkmcnt(0)
    global_store_dwordx4 v6, v[32:35], s[8:9] offset:0 sc1
    global_store_dwordx4 v6, v[36:39], s[8:9] offset:1024 sc1
    global_store_dwordx4 v6, v[40:43], s[8:9] offset:2048 sc1
    global_store_dwordx4 v6, v[44:47], s[8:9] offset:3072 sc1
.L_k1_end:
    s_endpgm
.globl k3_kernel
.p2align 8
.type k3_kernel,@function
k3_kernel:
    s_cmp_ge_u32 s2, 256
    s_cbranch_scc1 .L_k3_end
    s_load_dwordx2 s[12:13], s[0:1], 88
    s_load_dwordx4 s[32:35], s[0:1], 72
    v_and_b32 v9, 63, v0
    v_lshrrev_b32 v10, 6, v0
    v_lshlrev_b32 v1, 4, v9
    v_readfirstlane_b32 s14, v10
    v_mov_b32 v2, 163712
    v_mov_b32 v4, 0
    v_mov_b32 v5, 0
    v_mov_b32 v6, 0
    v_mov_b32 v7, 0
    ds_write_b128 v2, v[4:7]
    ds_write_b128 v2, v[4:7] offset:16
    ds_write_b128 v2, v[4:7] offset:32
    ds_write_b128 v2, v[4:7] offset:48
    s_waitcnt lgkmcnt(0)
    s_barrier
    s_cmp_ge_u32 s14, 4
    s_cbranch_scc1 .L_k3_prod
    v_and_b32 v1, 63, v0
    s_and_b32 s15, s2, 63
    s_lshr_b32 s16, s2, 6
    v_and_b32 v3, 15, v1
    v_lshrrev_b32 v4, 4, v1
    v_lshlrev_b32 v5, 4, v1
    s_lshl_b32 s17, s15, 15
    s_lshl_b32 s18, s14, 13
    s_add_u32 s17, s17, s18
    v_add_u32 v6, s17, v5
    v_add_u32 v7, 4096, v6
    s_and_b32 s24, s14, 1
    s_lshr_b32 s25, s14, 1
    s_lshl_b32 s19, s24, 5
    s_add_u32 s19, s19, s25
    v_lshl_add_u32 v8, v3, 1, s19
    s_lshl_b32 s19, s16, 3
    v_lshl_add_u32 v9, v4, 1, s19
    s_lshl_b32 s22, s25, 5
    v_add_u32 v10, s22, v9
    v_lshlrev_b32 v10, 15, v10
    v_lshl_add_u32 v10, v3, 4, v10
    s_lshl_b32 s22, s15, 9
    s_lshl_b32 s23, s24, 8
    s_add_u32 s22, s22, s23
    s_add_u32 s22, s22, 2097152
    v_add_u32 v10, s22, v10
    v_add_u32 v11, 0x8000, v10
    s_waitcnt lgkmcnt(0)
    global_load_dwordx4 v[32:35], v6, s[12:13] offset:0
    global_load_dwordx4 v[36:39], v6, s[12:13] offset:1024
    global_load_dwordx4 v[40:43], v6, s[12:13] offset:2048
    global_load_dwordx4 v[44:47], v6, s[12:13] offset:3072
    global_load_dwordx4 v[48:51], v7, s[12:13] offset:0
    global_load_dwordx4 v[52:55], v7, s[12:13] offset:1024
    global_load_dwordx4 v[56:59], v7, s[12:13] offset:2048
    global_load_dwordx4 v[60:63], v7, s[12:13] offset:3072
    global_load_dwordx4 v[64:67], v10, s[12:13]
    global_load_dwordx4 v[68:71], v11, s[12:13]
    v_lshrrev_b32 v13, 1, v3
    v_add_u32 v13, s19, v13
    v_and_b32 v14, 1, v3
    v_cvt_f32_u32 v15, v13
    v_cvt_f32_u32 v16, v14
    v_cvt_f32_u32 v17, v4
    v_mul_f32 v18, 0x3d000000, v15
    v_mul_f32 v19, 0x41000000, v17
    v_mul_f32 v19, v19, v18
    v_mul_f32 v20, 0x3e800000, v16
    v_add_f32 v19, v19, v20
    v_cos_f32 v24, v19
    v_add_f32 v19, v19, v18
    v_cos_f32 v25, v19
    v_add_f32 v19, v19, v18
    v_cos_f32 v26, v19
    v_add_f32 v19, v19, v18
    v_cos_f32 v27, v19
    v_add_f32 v19, v19, v18
    v_cos_f32 v28, v19
    v_add_f32 v19, v19, v18
    v_cos_f32 v29, v19
    v_add_f32 v19, v19, v18
    v_cos_f32 v30, v19
    v_add_f32 v19, v19, v18
    v_cos_f32 v31, v19
    s_nop 0
    v_cvt_pk_bf16_f32 v80, v24, v25
    v_cvt_pk_bf16_f32 v81, v26, v27
    v_cvt_pk_bf16_f32 v82, v28, v29
    v_cvt_pk_bf16_f32 v83, v30, v31
    v_mul_f32 v18, 0x3a000000, v15
    s_lshl_b32 s22, s14, 4
    v_lshl_add_u32 v19, v4, 2, s22
    v_cvt_f32_u32 v19, v19
    v_mul_f32 v19, v19, v18
    v_sub_f32 v21, v19, v20
    v_add_f32 v22, v19, v20
    v_subrev_f32 v22, 0x3e800000, v22
    v_fma_f32 v23, v16, -2.0, 1.0
    v_cos_f32 v84, v21
    v_cos_f32 v88, v22
    v_add_f32 v21, v21, v18
    v_add_f32 v22, v22, v18
    v_cos_f32 v85, v21
    v_cos_f32 v89, v22
    v_add_f32 v21, v21, v18
    v_add_f32 v22, v22, v18
    v_cos_f32 v86, v21
    v_cos_f32 v90, v22
    v_add_f32 v21, v21, v18
    v_add_f32 v22, v22, v18
    v_cos_f32 v87, v21
    v_cos_f32 v91, v22
    s_nop 0
    v_mul_f32 v92, v84, v23
    v_mul_f32 v93, v85, v23
    v_mul_f32 v94, v86, v23
    v_mul_f32 v95, v87, v23
    v_mul_f32 v96, v88, v23
    v_mul_f32 v97, v89, v23
    v_mul_f32 v98, v90, v23
    v_mul_f32 v99, v91, v23
    v_cvt_f32_u32 v18, v8
    v_mul_f32 v18, 0x3c800000, v18
    v_mul_f32 v19, 4.0, v17
    v_mul_f32 v19, v19, v18
    v_mul_f32 v20, 0x41500000, v18
    v_cos_f32 v24, v19
    v_sin_f32 v25, v19
    v_add_f32 v19, v19, v18
    v_cvt_pk_bf16_f32 v100, v24, v25
    v_cos_f32 v24, v19
    v_sin_f32 v25, v19
    v_add_f32 v19, v19, v18
    v_cvt_pk_bf16_f32 v101, v24, v25
    v_cos_f32 v24, v19
    v_sin_f32 v25, v19
    v_add_f32 v19, v19, v18
    v_cvt_pk_bf16_f32 v102, v24, v25
    v_cos_f32 v24, v19
    v_sin_f32 v25, v19
    v_add_f32 v19, v19, v20
    v_cvt_pk_bf16_f32 v103, v24, v25
    v_cos_f32 v24, v19
    v_sin_f32 v25, v19
    v_add_f32 v19, v19, v18
    v_cvt_pk_bf16_f32 v104, v24, v25
    v_cos_f32 v24, v19
    v_sin_f32 v25, v19
    v_add_f32 v19, v19, v18
    v_cvt_pk_bf16_f32 v105, v24, v25
    v_cos_f32 v24, v19
    v_sin_f32 v25, v19
    v_add_f32 v19, v19, v18
    v_cvt_pk_bf16_f32 v106, v24, v25
    v_cos_f32 v24, v19
    v_sin_f32 v25, v19
    v_add_f32 v19, v19, v20
    v_cvt_pk_bf16_f32 v107, v24, v25
    v_cos_f32 v24, v19
    v_sin_f32 v25, v19
    v_add_f32 v19, v19, v18
    v_cvt_pk_bf16_f32 v108, v24, v25
    v_cos_f32 v24, v19
    v_sin_f32 v25, v19
    v_add_f32 v19, v19, v18
    v_cvt_pk_bf16_f32 v109, v24, v25
    v_cos_f32 v24, v19
    v_sin_f32 v25, v19
    v_add_f32 v19, v19, v18
    v_cvt_pk_bf16_f32 v110, v24, v25
    v_cos_f32 v24, v19
    v_sin_f32 v25, v19
    v_add_f32 v19, v19, v20
    v_cvt_pk_bf16_f32 v111, v24, v25
    v_cos_f32 v24, v19
    v_sin_f32 v25, v19
    v_add_f32 v19, v19, v18
    v_cvt_pk_bf16_f32 v112, v24, v25
    v_cos_f32 v24, v19
    v_sin_f32 v25, v19
    v_add_f32 v19, v19, v18
    v_cvt_pk_bf16_f32 v113, v24, v25
    v_cos_f32 v24, v19
    v_sin_f32 v25, v19
    v_add_f32 v19, v19, v18
    v_cvt_pk_bf16_f32 v114, v24, v25
    v_cos_f32 v24, v19
    v_sin_f32 v25, v19
    v_add_f32 v19, v19, v20
    v_cvt_pk_bf16_f32 v115, v24, v25
    s_waitcnt vmcnt(9)
    v_mfma_f32_16x16x32_bf16 v[116:119], v[32:35], v[80:83], 0
    s_waitcnt vmcnt(8)
    v_mfma_f32_16x16x32_bf16 v[120:123], v[36:39], v[80:83], 0
    s_waitcnt vmcnt(7)
    v_mfma_f32_16x16x32_bf16 v[124:127], v[40:43], v[80:83], 0
    s_waitcnt vmcnt(6)
    v_mfma_f32_16x16x32_bf16 v[128:131], v[44:47], v[80:83], 0
    s_waitcnt vmcnt(5)
    v_mfma_f32_16x16x32_bf16 v[132:135], v[48:51], v[80:83], 0
    s_waitcnt vmcnt(4)
    v_mfma_f32_16x16x32_bf16 v[136:139], v[52:55], v[80:83], 0
    s_waitcnt vmcnt(3)
    v_mfma_f32_16x16x32_bf16 v[140:143], v[56:59], v[80:83], 0
    s_waitcnt vmcnt(2)
    v_mfma_f32_16x16x32_bf16 v[144:147], v[60:63], v[80:83], 0
    v_mov_b32 v12, 163764
    v_mov_b32 v13, 1
    s_mov_b64 s[36:37], exec
    s_mov_b64 exec, 1
    ds_add_u32 v12, v13
    s_mov_b64 exec, s[36:37]
    s_lshl_b32 s22, s14, 10
    v_add_u32 v15, s22, v5
    s_nop 5
    v_subrev_f32_dpp v16, v120, v116 quad_perm:[1,0,3,2] row_mask:0xf bank_mask:0xf
    v_add_f32_dpp v17, v116, v120 quad_perm:[1,0,3,2] row_mask:0xf bank_mask:0xf
    v_subrev_f32_dpp v18, v121, v117 quad_perm:[1,0,3,2] row_mask:0xf bank_mask:0xf
    v_add_f32_dpp v19, v117, v121 quad_perm:[1,0,3,2] row_mask:0xf bank_mask:0xf
    v_subrev_f32_dpp v20, v122, v118 quad_perm:[1,0,3,2] row_mask:0xf bank_mask:0xf
    v_add_f32_dpp v21, v118, v122 quad_perm:[1,0,3,2] row_mask:0xf bank_mask:0xf
    v_subrev_f32_dpp v22, v123, v119 quad_perm:[1,0,3,2] row_mask:0xf bank_mask:0xf
    v_add_f32_dpp v23, v119, v123 quad_perm:[1,0,3,2] row_mask:0xf bank_mask:0xf
    v_mul_f32 v24, v84, v16
    v_mul_f32 v25, v92, v17
    v_mul_f32 v26, v85, v18
    v_mul_f32 v27, v93, v19
    v_mul_f32 v28, v86, v20
    v_mul_f32 v29, v94, v21
    v_mul_f32 v30, v87, v22
    v_mul_f32 v31, v95, v23
    v_fmac_f32 v24, v88, v17
    v_fma_f32 v25, -v96, v16, v25
    v_fmac_f32 v26, v89, v19
    v_fma_f32 v27, -v97, v18, v27
    v_fmac_f32 v28, v90, v21
    v_fma_f32 v29, -v98, v20, v29
    v_fmac_f32 v30, v91, v23
    v_fma_f32 v31, -v99, v22, v31
    v_cvt_pk_bf16_f32 v32, v24, v25
    v_cvt_pk_bf16_f32 v33, v26, v27
    v_cvt_pk_bf16_f32 v34, v28, v29
    v_cvt_pk_bf16_f32 v35, v30, v31
    ds_write_b128 v15, v[32:35] offset:14336
    v_subrev_f32_dpp v16, v128, v124 quad_perm:[1,0,3,2] row_mask:0xf bank_mask:0xf
    v_add_f32_dpp v17, v124, v128 quad_perm:[1,0,3,2] row_mask:0xf bank_mask:0xf
    v_subrev_f32_dpp v18, v129, v125 quad_perm:[1,0,3,2] row_mask:0xf bank_mask:0xf
    v_add_f32_dpp v19, v125, v129 quad_perm:[1,0,3,2] row_mask:0xf bank_mask:0xf
    v_subrev_f32_dpp v20, v130, v126 quad_perm:[1,0,3,2] row_mask:0xf bank_mask:0xf
    v_add_f32_dpp v21, v126, v130 quad_perm:[1,0,3,2] row_mask:0xf bank_mask:0xf
    v_subrev_f32_dpp v22, v131, v127 quad_perm:[1,0,3,2] row_mask:0xf bank_mask:0xf
    v_add_f32_dpp v23, v127, v131 quad_perm:[1,0,3,2] row_mask:0xf bank_mask:0xf
    v_mul_f32 v24, v84, v16
    v_mul_f32 v25, v92, v17
    v_mul_f32 v26, v85, v18
    v_mul_f32 v27, v93, v19
    v_mul_f32 v28, v86, v20
    v_mul_f32 v29, v94, v21
    v_mul_f32 v30, v87, v22
    v_mul_f32 v31, v95, v23
    v_fmac_f32 v24, v88, v17
    v_fma_f32 v25, -v96, v16, v25
    v_fmac_f32 v26, v89, v19
    v_fma_f32 v27, -v97, v18, v27
    v_fmac_f32 v28, v90, v21
    v_fma_f32 v29, -v98, v20, v29
    v_fmac_f32 v30, v91, v23
    v_fma_f32 v31, -v99, v22, v31
    v_cvt_pk_bf16_f32 v36, v24, v25
    v_cvt_pk_bf16_f32 v37, v26, v27
    v_cvt_pk_bf16_f32 v38, v28, v29
    v_cvt_pk_bf16_f32 v39, v30, v31
    ds_write_b128 v15, v[36:39] offset:18432
    v_subrev_f32_dpp v16, v136, v132 quad_perm:[1,0,3,2] row_mask:0xf bank_mask:0xf
    v_add_f32_dpp v17, v132, v136 quad_perm:[1,0,3,2] row_mask:0xf bank_mask:0xf
    v_subrev_f32_dpp v18, v137, v133 quad_perm:[1,0,3,2] row_mask:0xf bank_mask:0xf
    v_add_f32_dpp v19, v133, v137 quad_perm:[1,0,3,2] row_mask:0xf bank_mask:0xf
    v_subrev_f32_dpp v20, v138, v134 quad_perm:[1,0,3,2] row_mask:0xf bank_mask:0xf
    v_add_f32_dpp v21, v134, v138 quad_perm:[1,0,3,2] row_mask:0xf bank_mask:0xf
    v_subrev_f32_dpp v22, v139, v135 quad_perm:[1,0,3,2] row_mask:0xf bank_mask:0xf
    v_add_f32_dpp v23, v135, v139 quad_perm:[1,0,3,2] row_mask:0xf bank_mask:0xf
    v_mul_f32 v24, v84, v16
    v_mul_f32 v25, v92, v17
    v_mul_f32 v26, v85, v18
    v_mul_f32 v27, v93, v19
    v_mul_f32 v28, v86, v20
    v_mul_f32 v29, v94, v21
    v_mul_f32 v30, v87, v22
    v_mul_f32 v31, v95, v23
    v_fmac_f32 v24, v88, v17
    v_fma_f32 v25, -v96, v16, v25
    v_fmac_f32 v26, v89, v19
    v_fma_f32 v27, -v97, v18, v27
    v_fmac_f32 v28, v90, v21
    v_fma_f32 v29, -v98, v20, v29
    v_fmac_f32 v30, v91, v23
    v_fma_f32 v31, -v99, v22, v31
    v_cvt_pk_bf16_f32 v40, v24, v25
    v_cvt_pk_bf16_f32 v41, v26, v27
    v_cvt_pk_bf16_f32 v42, v28, v29
    v_cvt_pk_bf16_f32 v43, v30, v31
    ds_write_b128 v15, v[40:43] offset:36864
    v_subrev_f32_dpp v16, v144, v140 quad_perm:[1,0,3,2] row_mask:0xf bank_mask:0xf
    v_add_f32_dpp v17, v140, v144 quad_perm:[1,0,3,2] row_mask:0xf bank_mask:0xf
    v_subrev_f32_dpp v18, v145, v141 quad_perm:[1,0,3,2] row_mask:0xf bank_mask:0xf
    v_add_f32_dpp v19, v141, v145 quad_perm:[1,0,3,2] row_mask:0xf bank_mask:0xf
    v_subrev_f32_dpp v20, v146, v142 quad_perm:[1,0,3,2] row_mask:0xf bank_mask:0xf
    v_add_f32_dpp v21, v142, v146 quad_perm:[1,0,3,2] row_mask:0xf bank_mask:0xf
    v_subrev_f32_dpp v22, v147, v143 quad_perm:[1,0,3,2] row_mask:0xf bank_mask:0xf
    v_add_f32_dpp v23, v143, v147 quad_perm:[1,0,3,2] row_mask:0xf bank_mask:0xf
    v_mul_f32 v24, v84, v16
    v_mul_f32 v25, v92, v17
    v_mul_f32 v26, v85, v18
    v_mul_f32 v27, v93, v19
    v_mul_f32 v28, v86, v20
    v_mul_f32 v29, v94, v21
    v_mul_f32 v30, v87, v22
    v_mul_f32 v31, v95, v23
    v_fmac_f32 v24, v88, v17
    v_fma_f32 v25, -v96, v16, v25
    v_fmac_f32 v26, v89, v19
    v_fma_f32 v27, -v97, v18, v27
    v_fmac_f32 v28, v90, v21
    v_fma_f32 v29, -v98, v20, v29
    v_fmac_f32 v30, v91, v23
    v_fma_f32 v31, -v99, v22, v31
    v_cvt_pk_bf16_f32 v44, v24, v25
    v_cvt_pk_bf16_f32 v45, v26, v27
    v_cvt_pk_bf16_f32 v46, v28, v29
    v_cvt_pk_bf16_f32 v47, v30, v31
    ds_write_b128 v15, v[44:47] offset:40960
    s_waitcnt lgkmcnt(0)
    v_mov_b32 v12, 163728
    v_mov_b32 v13, 1
    s_mov_b64 s[36:37], exec
    s_mov_b64 exec, 1
    ds_add_u32 v12, v13
    s_mov_b64 exec, s[36:37]
    s_mov_b32 s39, 0
.rb_k3_kernel_1:
    ds_read_b32 v13, v12
    s_waitcnt lgkmcnt(0)
    v_readfirstlane_b32 s38, v13
    s_add_u32 s39, s39, 1
    s_cmp_ge_u32 s38, 4
    s_cbranch_scc1 .rbe_k3_kernel_2
    s_cmp_lt_u32 s39, 1600000
    s_cbranch_scc1 .rb_k3_kernel_1
.rbe_k3_kernel_2:
    ds_read_b128 v[116:119], v5 offset:14336
    ds_read_b128 v[120:123], v5 offset:15360
    ds_read_b128 v[124:127], v5 offset:16384
    ds_read_b128 v[128:131], v5 offset:17408
    ds_read_b128 v[132:135], v5 offset:18432
    ds_read_b128 v[136:139], v5 offset:19456
    ds_read_b128 v[140:143], v5 offset:20480
    ds_read_b128 v[144:147], v5 offset:21504
    s_waitcnt lgkmcnt(7)
    v_mfma_f32_16x16x32_bf16 v[48:51], v[116:119], v[100:103], 0
    s_waitcnt lgkmcnt(6)
    v_mfma_f32_16x16x32_bf16 v[48:51], v[120:123], v[104:107], v[48:51]
    s_waitcnt lgkmcnt(5)
    v_mfma_f32_16x16x32_bf16 v[48:51], v[124:127], v[108:111], v[48:51]
    s_waitcnt lgkmcnt(4)
    v_mfma_f32_16x16x32_bf16 v[48:51], v[128:131], v[112:115], v[48:51]
    s_waitcnt lgkmcnt(3)
    v_mfma_f32_16x16x32_bf16 v[52:55], v[132:135], v[100:103], 0
    s_waitcnt lgkmcnt(2)
    v_mfma_f32_16x16x32_bf16 v[52:55], v[136:139], v[104:107], v[52:55]
    s_waitcnt lgkmcnt(1)
    v_mfma_f32_16x16x32_bf16 v[52:55], v[140:143], v[108:111], v[52:55]
    s_waitcnt lgkmcnt(0)
    v_mfma_f32_16x16x32_bf16 v[52:55], v[144:147], v[112:115], v[52:55]
    ds_read_b128 v[148:151], v5 offset:36864
    ds_read_b128 v[152:155], v5 offset:37888
    ds_read_b128 v[156:159], v5 offset:38912
    ds_read_b128 v[160:163], v5 offset:39936
    ds_read_b128 v[164:167], v5 offset:40960
    ds_read_b128 v[168:171], v5 offset:41984
    ds_read_b128 v[172:175], v5 offset:43008
    ds_read_b128 v[176:179], v5 offset:44032
    s_waitcnt lgkmcnt(7)
    v_mfma_f32_16x16x32_bf16 v[56:59], v[148:151], v[100:103], 0
    s_waitcnt lgkmcnt(6)
    v_mfma_f32_16x16x32_bf16 v[56:59], v[152:155], v[104:107], v[56:59]
    s_waitcnt lgkmcnt(5)
    v_mfma_f32_16x16x32_bf16 v[56:59], v[156:159], v[108:111], v[56:59]
    s_waitcnt lgkmcnt(4)
    v_mfma_f32_16x16x32_bf16 v[56:59], v[160:163], v[112:115], v[56:59]
    s_waitcnt lgkmcnt(3)
    v_mfma_f32_16x16x32_bf16 v[60:63], v[164:167], v[100:103], 0
    s_waitcnt lgkmcnt(2)
    v_mfma_f32_16x16x32_bf16 v[60:63], v[168:171], v[104:107], v[60:63]
    s_waitcnt lgkmcnt(1)
    v_mfma_f32_16x16x32_bf16 v[60:63], v[172:175], v[108:111], v[60:63]
    s_waitcnt lgkmcnt(0)
    v_mfma_f32_16x16x32_bf16 v[60:63], v[176:179], v[112:115], v[60:63]
    s_waitcnt vmcnt(0)
    s_cmp_lg_u32 s15, 63
    s_cbranch_scc1 .L_k2_n63
    s_nop 7
    v_mov_b32 v60, 0
    v_mov_b32 v62, 0
.L_k2_n63:
    s_nop 7
    s_mov_b32 s22, 0xffff0000
    v_lshlrev_b32 v16, 16, v64
    v_and_b32 v17, s22, v64
    v_lshlrev_b32 v18, 16, v65
    v_and_b32 v19, s22, v65
    v_lshlrev_b32 v20, 16, v66
    v_and_b32 v21, s22, v66
    v_lshlrev_b32 v22, 16, v67
    v_and_b32 v23, s22, v67
    v_add_f32 v16, v16, v48
    v_add_f32 v17, v17, v52
    v_add_f32 v18, v18, v56
    v_add_f32 v19, v19, v60
    v_add_f32 v20, v20, v61
    v_add_f32 v21, v21, v57
    v_add_f32 v22, v22, v53
    v_add_f32 v23, v23, v49
    v_cvt_pk_bf16_f32 v24, v16, v17
    v_cvt_pk_bf16_f32 v25, v18, v19
    v_cvt_pk_bf16_f32 v26, v20, v21
    v_cvt_pk_bf16_f32 v27, v22, v23
    global_store_dwordx4 v10, v[24:27], s[12:13] sc1
    v_lshlrev_b32 v16, 16, v68
    v_and_b32 v17, s22, v68
    v_lshlrev_b32 v18, 16, v69
    v_and_b32 v19, s22, v69
    v_lshlrev_b32 v20, 16, v70
    v_and_b32 v21, s22, v70
    v_lshlrev_b32 v22, 16, v71
    v_and_b32 v23, s22, v71
    v_add_f32 v16, v16, v50
    v_add_f32 v17, v17, v54
    v_add_f32 v18, v18, v58
    v_add_f32 v19, v19, v62
    v_add_f32 v20, v20, v63
    v_add_f32 v21, v21, v59
    v_add_f32 v22, v22, v55
    v_add_f32 v23, v23, v51
    v_cvt_pk_bf16_f32 v28, v16, v17
    v_cvt_pk_bf16_f32 v29, v18, v19
    v_cvt_pk_bf16_f32 v30, v20, v21
    v_cvt_pk_bf16_f32 v31, v22, v23
    global_store_dwordx4 v11, v[28:31], s[12:13] sc1
    s_lshl_b32 s43, s16, 4
    s_lshr_b32 s17, s15, 2
    s_add_u32 s43, s43, s17
    s_lshl_b32 s43, s43, 8
    s_add_u32 s43, s43, 18890752
    s_waitcnt vmcnt(0)
    v_mov_b32 v12, 163720
    v_mov_b32 v13, 1
    s_mov_b64 s[36:37], exec
    s_mov_b64 exec, 1
    ds_add_rtn_u32 v14, v12, v13
    s_waitcnt lgkmcnt(0)
    v_readfirstlane_b32 s38, v14
    s_nop 3
    s_cmp_lg_u32 s38, 3
    s_cbranch_scc1 .sig_k3_kernel_3
    v_mov_b32 v12, s43
    global_atomic_add v12, v13, s[12:13] sc1
.sig_k3_kernel_3:
    s_mov_b64 exec, s[36:37]
    v_and_b32 v9, 63, v0
    v_lshlrev_b32 v1, 4, v9
    s_and_b32 s15, s2, 7
    s_lshr_b32 s16, s2, 3
    s_and_b32 s17, s15, 1
    s_lshl_b32 s17, s17, 3
    s_and_b32 s18, s16, 7
    s_add_u32 s40, s17, s18
    s_lshr_b32 s18, s15, 1
    s_lshl_b32 s18, s18, 2
    s_lshr_b32 s19, s16, 3
    s_add_u32 s18, s18, s19
    s_and_b32 s24, s14, 3
    s_lshl_b32 s17, s40, 2
    s_add_u32 s17, s17, s24
    s_and_b32 s41, s15, 1
    s_lshl_b32 s41, s41, 2
    s_and_b32 s19, s16, 3
    s_add_u32 s41, s41, s19
    s_lshr_b32 s42, s15, 1
    s_lshl_b32 s42, s42, 3
    s_lshr_b32 s19, s16, 2
    s_add_u32 s42, s42, s19
    v_mov_b32 v2, v1
    v_add_u32 v3, 57344, v1
    v_add_u32 v4, 114688, v1
    s_lshl_b32 s20, s24, 10
    v_add_u32 v10, s20, v2
    v_add_u32 v11, s20, v3
    v_add_u32 v12, s20, v4
    v_mov_b32 v16, 0
    v_mov_b32 v17, 0
    v_mov_b32 v18, 0
    v_mov_b32 v19, 0
    v_mov_b32 v20, 0
    v_mov_b32 v21, 0
    v_mov_b32 v22, 0
    v_mov_b32 v23, 0
    v_mov_b32 v24, 0
    v_mov_b32 v25, 0
    v_mov_b32 v26, 0
    v_mov_b32 v27, 0
    v_mov_b32 v28, 0
    v_mov_b32 v29, 0
    v_mov_b32 v30, 0
    v_mov_b32 v31, 0
    v_mov_b32 v32, 0
    v_mov_b32 v33, 0
    v_mov_b32 v34, 0
    v_mov_b32 v35, 0
    v_mov_b32 v36, 0
    v_mov_b32 v37, 0
    v_mov_b32 v38, 0
    v_mov_b32 v39, 0
    v_mov_b32 v40, 0
    v_mov_b32 v41, 0
    v_mov_b32 v42, 0
    v_mov_b32 v43, 0
    v_mov_b32 v44, 0
    v_mov_b32 v45, 0
    v_mov_b32 v46, 0
    v_mov_b32 v47, 0
    v_mov_b32 v48, 0
    v_mov_b32 v49, 0
    v_mov_b32 v50, 0
    v_mov_b32 v51, 0
    v_mov_b32 v52, 0
    v_mov_b32 v53, 0
    v_mov_b32 v54, 0
    v_mov_b32 v55, 0
    v_mov_b32 v56, 0
    v_mov_b32 v57, 0
    v_mov_b32 v58, 0
    v_mov_b32 v59, 0
    v_mov_b32 v60, 0
    v_mov_b32 v61, 0
    v_mov_b32 v62, 0
    v_mov_b32 v63, 0
    v_mov_b32 v64, 0
    v_mov_b32 v65, 0
    v_mov_b32 v66, 0
    v_mov_b32 v67, 0
    v_mov_b32 v68, 0
    v_mov_b32 v69, 0
    v_mov_b32 v70, 0
    v_mov_b32 v71, 0
    v_mov_b32 v72, 0
    v_mov_b32 v73, 0
    v_mov_b32 v74, 0
    v_mov_b32 v75, 0
    v_mov_b32 v76, 0
    v_mov_b32 v77, 0
    v_mov_b32 v78, 0
    v_mov_b32 v79, 0
    v_mov_b32 v80, 0
    v_mov_b32 v81, 0
    v_mov_b32 v82, 0
    v_mov_b32 v83, 0
    v_mov_b32 v84, 0
    v_mov_b32 v85, 0
    v_mov_b32 v86, 0
    v_mov_b32 v87, 0
    v_mov_b32 v88, 0
    v_mov_b32 v89, 0
    v_mov_b32 v90, 0
    v_mov_b32 v91, 0
    v_mov_b32 v92, 0
    v_mov_b32 v93, 0
    v_mov_b32 v94, 0
    v_mov_b32 v95, 0
    v_mov_b32 v96, 0
    v_mov_b32 v97, 0
    v_mov_b32 v98, 0
    v_mov_b32 v99, 0
    v_mov_b32 v100, 0
    v_mov_b32 v101, 0
    v_mov_b32 v102, 0
    v_mov_b32 v103, 0
    v_mov_b32 v104, 0
    v_mov_b32 v105, 0
    v_mov_b32 v106, 0
    v_mov_b32 v107, 0
    v_mov_b32 v108, 0
    v_mov_b32 v109, 0
    v_mov_b32 v110, 0
    v_mov_b32 v111, 0
    v_mov_b32 v112, 0
    v_mov_b32 v113, 0
    v_mov_b32 v114, 0
    v_mov_b32 v115, 0
    v_mov_b32 v116, 0
    v_mov_b32 v117, 0
    v_mov_b32 v118, 0
    v_mov_b32 v119, 0
    v_mov_b32 v120, 0
    v_mov_b32 v121, 0
    v_mov_b32 v122, 0
    v_mov_b32 v123, 0
    v_mov_b32 v124, 0
    v_mov_b32 v125, 0
    v_mov_b32 v126, 0
    v_mov_b32 v127, 0
    v_mov_b32 v5, 0
    v_mov_b32 v6, 0
    v_mov_b32 v7, 0
    v_mov_b32 v8, 0
    s_mov_b32 s30, 0xffff0000
    s_barrier
    ds_read_b128 v[160:163], v10 offset:14336
    ds_read_b128 v[128:131], v2 offset:0
    ds_read_b128 v[132:135], v2 offset:1024
    ds_read_b128 v[136:139], v2 offset:2048
    ds_read_b128 v[140:143], v2 offset:3072
    ds_read_b128 v[144:147], v2 offset:4096
    ds_read_b128 v[148:151], v2 offset:5120
    ds_read_b128 v[152:155], v2 offset:6144
    s_waitcnt lgkmcnt(6)
    v_mfma_f32_32x32x16_bf16 v[16:31], v[128:131], v[160:163], v[16:31]
    ds_read_b128 v[164:167], v10 offset:18432
    ds_read_b128 v[156:159], v2 offset:7168
    v_lshlrev_b32 v176, 16, v160
    v_and_b32 v177, s30, v160
    v_lshlrev_b32 v178, 16, v161
    v_and_b32 v179, s30, v161
    s_waitcnt lgkmcnt(7)
    v_mfma_f32_32x32x16_bf16 v[32:47], v[132:135], v[160:163], v[32:47]
    ds_read_b128 v[128:131], v2 offset:8192
    v_lshlrev_b32 v180, 16, v162
    v_and_b32 v181, s30, v162
    v_lshlrev_b32 v182, 16, v163
    v_and_b32 v183, s30, v163
    s_waitcnt lgkmcnt(7)
    v_mfma_f32_32x32x16_bf16 v[48:63], v[136:139], v[160:163], v[48:63]
    ds_read_b128 v[132:135], v2 offset:9216
    v_add_f32 v5, v5, v176
    v_add_f32 v6, v6, v177
    v_fmac_f32 v7, v176, v176
    v_fmac_f32 v8, v177, v177
    s_waitcnt lgkmcnt(7)
    v_mfma_f32_32x32x16_bf16 v[64:79], v[140:143], v[160:163], v[64:79]
    ds_read_b128 v[136:139], v2 offset:10240
    v_add_f32 v5, v5, v178
    v_add_f32 v6, v6, v179
    v_fmac_f32 v7, v178, v178
    s_waitcnt lgkmcnt(7)
    v_mfma_f32_32x32x16_bf16 v[80:95], v[144:147], v[160:163], v[80:95]
    ds_read_b128 v[140:143], v2 offset:11264
    v_fmac_f32 v8, v179, v179
    v_add_f32 v5, v5, v180
    v_add_f32 v6, v6, v181
    s_waitcnt lgkmcnt(7)
    v_mfma_f32_32x32x16_bf16 v[96:111], v[148:151], v[160:163], v[96:111]
    ds_read_b128 v[144:147], v2 offset:12288
    v_fmac_f32 v7, v180, v180
    v_fmac_f32 v8, v181, v181
    v_add_f32 v5, v5, v182
    s_waitcnt lgkmcnt(7)
    v_mfma_f32_32x32x16_bf16 v[112:127], v[152:155], v[160:163], v[112:127]
    ds_read_b128 v[148:151], v2 offset:13312
    v_add_f32 v6, v6, v183
    v_fmac_f32 v7, v182, v182
    v_fmac_f32 v8, v183, v183
    s_waitcnt lgkmcnt(6)
    v_mfma_f32_32x32x16_bf16 v[16:31], v[156:159], v[164:167], v[16:31]
    s_barrier
    ds_read_b128 v[168:171], v10 offset:36864
    ds_read_b128 v[152:155], v2 offset:22528
    v_lshlrev_b32 v176, 16, v164
    v_and_b32 v177, s30, v164
    v_lshlrev_b32 v178, 16, v165
    v_and_b32 v179, s30, v165
    s_waitcnt lgkmcnt(7)
    v_mfma_f32_32x32x16_bf16 v[32:47], v[128:131], v[164:167], v[32:47]
    ds_read_b128 v[156:159], v2 offset:23552
    v_lshlrev_b32 v180, 16, v166
    v_and_b32 v181, s30, v166
    v_lshlrev_b32 v182, 16, v167
    v_and_b32 v183, s30, v167
    s_waitcnt lgkmcnt(7)
    v_mfma_f32_32x32x16_bf16 v[48:63], v[132:135], v[164:167], v[48:63]
    ds_read_b128 v[128:131], v2 offset:24576
    v_add_f32 v5, v5, v176
    v_add_f32 v6, v6, v177
    v_fmac_f32 v7, v176, v176
    v_fmac_f32 v8, v177, v177
    s_waitcnt lgkmcnt(7)
    v_mfma_f32_32x32x16_bf16 v[64:79], v[136:139], v[164:167], v[64:79]
    ds_read_b128 v[132:135], v2 offset:25600
    v_add_f32 v5, v5, v178
    v_add_f32 v6, v6, v179
    v_fmac_f32 v7, v178, v178
    s_waitcnt lgkmcnt(7)
    v_mfma_f32_32x32x16_bf16 v[80:95], v[140:143], v[164:167], v[80:95]
    ds_read_b128 v[136:139], v2 offset:26624
    v_fmac_f32 v8, v179, v179
    v_add_f32 v5, v5, v180
    v_add_f32 v6, v6, v181
    s_waitcnt lgkmcnt(7)
    v_mfma_f32_32x32x16_bf16 v[96:111], v[144:147], v[164:167], v[96:111]
    ds_read_b128 v[140:143], v2 offset:27648
    v_fmac_f32 v7, v180, v180
    v_fmac_f32 v8, v181, v181
    v_add_f32 v5, v5, v182
    s_waitcnt lgkmcnt(7)
    v_mfma_f32_32x32x16_bf16 v[112:127], v[148:151], v[164:167], v[112:127]
    ds_read_b128 v[144:147], v2 offset:28672
    v_add_f32 v6, v6, v183
    v_fmac_f32 v7, v182, v182
    v_fmac_f32 v8, v183, v183
    s_waitcnt lgkmcnt(6)
    v_mfma_f32_32x32x16_bf16 v[16:31], v[152:155], v[168:171], v[16:31]
    ds_read_b128 v[172:175], v10 offset:40960
    ds_read_b128 v[148:151], v2 offset:29696
    v_lshlrev_b32 v176, 16, v168
    v_and_b32 v177, s30, v168
    v_lshlrev_b32 v178, 16, v169
    v_and_b32 v179, s30, v169
    s_waitcnt lgkmcnt(7)
    v_mfma_f32_32x32x16_bf16 v[32:47], v[156:159], v[168:171], v[32:47]
    ds_read_b128 v[152:155], v2 offset:30720
    v_lshlrev_b32 v180, 16, v170
    v_and_b32 v181, s30, v170
    v_lshlrev_b32 v182, 16, v171
    v_and_b32 v183, s30, v171
    s_waitcnt lgkmcnt(7)
    v_mfma_f32_32x32x16_bf16 v[48:63], v[128:131], v[168:171], v[48:63]
    ds_read_b128 v[156:159], v2 offset:31744
    v_add_f32 v5, v5, v176
    v_add_f32 v6, v6, v177
    v_fmac_f32 v7, v176, v176
    v_fmac_f32 v8, v177, v177
    s_waitcnt lgkmcnt(7)
    v_mfma_f32_32x32x16_bf16 v[64:79], v[132:135], v[168:171], v[64:79]
    ds_read_b128 v[128:131], v2 offset:32768
    v_add_f32 v5, v5, v178
    v_add_f32 v6, v6, v179
    v_fmac_f32 v7, v178, v178
    s_waitcnt lgkmcnt(7)
    v_mfma_f32_32x32x16_bf16 v[80:95], v[136:139], v[168:171], v[80:95]
    ds_read_b128 v[132:135], v2 offset:33792
    v_fmac_f32 v8, v179, v179
    v_add_f32 v5, v5, v180
    v_add_f32 v6, v6, v181
    s_waitcnt lgkmcnt(7)
    v_mfma_f32_32x32x16_bf16 v[96:111], v[140:143], v[168:171], v[96:111]
    ds_read_b128 v[136:139], v2 offset:34816
    v_fmac_f32 v7, v180, v180
    v_fmac_f32 v8, v181, v181
    v_add_f32 v5, v5, v182
    s_waitcnt lgkmcnt(7)
    v_mfma_f32_32x32x16_bf16 v[112:127], v[144:147], v[168:171], v[112:127]
    ds_read_b128 v[140:143], v2 offset:35840
    v_add_f32 v6, v6, v183
    v_fmac_f32 v7, v182, v182
    v_fmac_f32 v8, v183, v183
    s_waitcnt lgkmcnt(6)
    v_mfma_f32_32x32x16_bf16 v[16:31], v[148:151], v[172:175], v[16:31]
    s_barrier
    ds_read_b128 v[160:163], v11 offset:2048
    ds_read_b128 v[144:147], v2 offset:45056
    v_lshlrev_b32 v176, 16, v172
    v_and_b32 v177, s30, v172
    v_lshlrev_b32 v178, 16, v173
    v_and_b32 v179, s30, v173
    s_waitcnt lgkmcnt(7)
    v_mfma_f32_32x32x16_bf16 v[32:47], v[152:155], v[172:175], v[32:47]
    ds_read_b128 v[148:151], v2 offset:46080
    v_lshlrev_b32 v180, 16, v174
    v_and_b32 v181, s30, v174
    v_lshlrev_b32 v182, 16, v175
    v_and_b32 v183, s30, v175
    s_waitcnt lgkmcnt(7)
    v_mfma_f32_32x32x16_bf16 v[48:63], v[156:159], v[172:175], v[48:63]
    ds_read_b128 v[152:155], v2 offset:47104
    v_add_f32 v5, v5, v176
    v_add_f32 v6, v6, v177
    v_fmac_f32 v7, v176, v176
    v_fmac_f32 v8, v177, v177
    s_waitcnt lgkmcnt(7)
    v_mfma_f32_32x32x16_bf16 v[64:79], v[128:131], v[172:175], v[64:79]
    ds_read_b128 v[156:159], v2 offset:48128
    v_add_f32 v5, v5, v178
    v_add_f32 v6, v6, v179
    v_fmac_f32 v7, v178, v178
    s_waitcnt lgkmcnt(7)
    v_mfma_f32_32x32x16_bf16 v[80:95], v[132:135], v[172:175], v[80:95]
    ds_read_b128 v[128:131], v2 offset:49152
    v_fmac_f32 v8, v179, v179
    v_add_f32 v5, v5, v180
    v_add_f32 v6, v6, v181
    s_waitcnt lgkmcnt(7)
    v_mfma_f32_32x32x16_bf16 v[96:111], v[136:139], v[172:175], v[96:111]
    ds_read_b128 v[132:135], v2 offset:50176
    v_fmac_f32 v7, v180, v180
    v_fmac_f32 v8, v181, v181
    v_add_f32 v5, v5, v182
    s_waitcnt lgkmcnt(7)
    v_mfma_f32_32x32x16_bf16 v[112:127], v[140:143], v[172:175], v[112:127]
    ds_read_b128 v[136:139], v2 offset:51200
    v_add_f32 v6, v6, v183
    v_fmac_f32 v7, v182, v182
    v_fmac_f32 v8, v183, v183
    s_waitcnt lgkmcnt(6)
    v_mfma_f32_32x32x16_bf16 v[16:31], v[144:147], v[160:163], v[16:31]
    ds_read_b128 v[164:167], v11 offset:6144
    ds_read_b128 v[140:143], v2 offset:52224
    v_lshlrev_b32 v176, 16, v160
    v_and_b32 v177, s30, v160
    v_lshlrev_b32 v178, 16, v161
    v_and_b32 v179, s30, v161
    s_waitcnt lgkmcnt(7)
    v_mfma_f32_32x32x16_bf16 v[32:47], v[148:151], v[160:163], v[32:47]
    ds_read_b128 v[144:147], v2 offset:53248
    v_lshlrev_b32 v180, 16, v162
    v_and_b32 v181, s30, v162
    v_lshlrev_b32 v182, 16, v163
    v_and_b32 v183, s30, v163
    s_waitcnt lgkmcnt(7)
    v_mfma_f32_32x32x16_bf16 v[48:63], v[152:155], v[160:163], v[48:63]
    ds_read_b128 v[148:151], v2 offset:54272
    v_add_f32 v5, v5, v176
    v_add_f32 v6, v6, v177
    v_fmac_f32 v7, v176, v176
    v_fmac_f32 v8, v177, v177
    s_waitcnt lgkmcnt(7)
    v_mfma_f32_32x32x16_bf16 v[64:79], v[156:159], v[160:163], v[64:79]
    ds_read_b128 v[152:155], v2 offset:55296
    v_add_f32 v5, v5, v178
    v_add_f32 v6, v6, v179
    v_fmac_f32 v7, v178, v178
    s_waitcnt lgkmcnt(7)
    v_mfma_f32_32x32x16_bf16 v[80:95], v[128:131], v[160:163], v[80:95]
    ds_read_b128 v[156:159], v2 offset:56320
    v_fmac_f32 v8, v179, v179
    v_add_f32 v5, v5, v180
    v_add_f32 v6, v6, v181
    s_waitcnt lgkmcnt(7)
    v_mfma_f32_32x32x16_bf16 v[96:111], v[132:135], v[160:163], v[96:111]
    ds_read_b128 v[128:131], v3 offset:0
    v_fmac_f32 v7, v180, v180
    v_fmac_f32 v8, v181, v181
    v_add_f32 v5, v5, v182
    s_waitcnt lgkmcnt(7)
    v_mfma_f32_32x32x16_bf16 v[112:127], v[136:139], v[160:163], v[112:127]
    ds_read_b128 v[132:135], v3 offset:1024
    v_add_f32 v6, v6, v183
    v_fmac_f32 v7, v182, v182
    v_fmac_f32 v8, v183, v183
    s_waitcnt lgkmcnt(6)
    v_mfma_f32_32x32x16_bf16 v[16:31], v[140:143], v[164:167], v[16:31]
    s_barrier
    ds_read_b128 v[168:171], v11 offset:24576
    ds_read_b128 v[136:139], v3 offset:10240
    v_lshlrev_b32 v176, 16, v164
    v_and_b32 v177, s30, v164
    v_lshlrev_b32 v178, 16, v165
    v_and_b32 v179, s30, v165
    s_waitcnt lgkmcnt(7)
    v_mfma_f32_32x32x16_bf16 v[32:47], v[144:147], v[164:167], v[32:47]
    ds_read_b128 v[140:143], v3 offset:11264
    v_lshlrev_b32 v180, 16, v166
    v_and_b32 v181, s30, v166
    v_lshlrev_b32 v182, 16, v167
    v_and_b32 v183, s30, v167
    s_waitcnt lgkmcnt(7)
    v_mfma_f32_32x32x16_bf16 v[48:63], v[148:151], v[164:167], v[48:63]
    ds_read_b128 v[144:147], v3 offset:12288
    v_add_f32 v5, v5, v176
    v_add_f32 v6, v6, v177
    v_fmac_f32 v7, v176, v176
    v_fmac_f32 v8, v177, v177
    s_waitcnt lgkmcnt(7)
    v_mfma_f32_32x32x16_bf16 v[64:79], v[152:155], v[164:167], v[64:79]
    ds_read_b128 v[148:151], v3 offset:13312
    v_add_f32 v5, v5, v178
    v_add_f32 v6, v6, v179
    v_fmac_f32 v7, v178, v178
    s_waitcnt lgkmcnt(7)
    v_mfma_f32_32x32x16_bf16 v[80:95], v[156:159], v[164:167], v[80:95]
    ds_read_b128 v[152:155], v3 offset:14336
    v_fmac_f32 v8, v179, v179
    v_add_f32 v5, v5, v180
    v_add_f32 v6, v6, v181
    s_waitcnt lgkmcnt(7)
    v_mfma_f32_32x32x16_bf16 v[96:111], v[128:131], v[164:167], v[96:111]
    ds_read_b128 v[156:159], v3 offset:15360
    v_fmac_f32 v7, v180, v180
    v_fmac_f32 v8, v181, v181
    v_add_f32 v5, v5, v182
    s_waitcnt lgkmcnt(7)
    v_mfma_f32_32x32x16_bf16 v[112:127], v[132:135], v[164:167], v[112:127]
    ds_read_b128 v[128:131], v3 offset:16384
    v_add_f32 v6, v6, v183
    v_fmac_f32 v7, v182, v182
    v_fmac_f32 v8, v183, v183
    s_waitcnt lgkmcnt(6)
    v_mfma_f32_32x32x16_bf16 v[16:31], v[136:139], v[168:171], v[16:31]
    ds_read_b128 v[172:175], v11 offset:28672
    ds_read_b128 v[132:135], v3 offset:17408
    v_lshlrev_b32 v176, 16, v168
    v_and_b32 v177, s30, v168
    v_lshlrev_b32 v178, 16, v169
    v_and_b32 v179, s30, v169
    s_waitcnt lgkmcnt(7)
    v_mfma_f32_32x32x16_bf16 v[32:47], v[140:143], v[168:171], v[32:47]
    ds_read_b128 v[136:139], v3 offset:18432
    v_lshlrev_b32 v180, 16, v170
    v_and_b32 v181, s30, v170
    v_lshlrev_b32 v182, 16, v171
    v_and_b32 v183, s30, v171
    s_waitcnt lgkmcnt(7)
    v_mfma_f32_32x32x16_bf16 v[48:63], v[144:147], v[168:171], v[48:63]
    ds_read_b128 v[140:143], v3 offset:19456
    v_add_f32 v5, v5, v176
    v_add_f32 v6, v6, v177
    v_fmac_f32 v7, v176, v176
    v_fmac_f32 v8, v177, v177
    s_waitcnt lgkmcnt(7)
    v_mfma_f32_32x32x16_bf16 v[64:79], v[148:151], v[168:171], v[64:79]
    ds_read_b128 v[144:147], v3 offset:20480
    v_add_f32 v5, v5, v178
    v_add_f32 v6, v6, v179
    v_fmac_f32 v7, v178, v178
    s_waitcnt lgkmcnt(7)
    v_mfma_f32_32x32x16_bf16 v[80:95], v[152:155], v[168:171], v[80:95]
    ds_read_b128 v[148:151], v3 offset:21504
    v_fmac_f32 v8, v179, v179
    v_add_f32 v5, v5, v180
    v_add_f32 v6, v6, v181
    s_waitcnt lgkmcnt(7)
    v_mfma_f32_32x32x16_bf16 v[96:111], v[156:159], v[168:171], v[96:111]
    ds_read_b128 v[152:155], v3 offset:22528
    v_fmac_f32 v7, v180, v180
    v_fmac_f32 v8, v181, v181
    v_add_f32 v5, v5, v182
    s_waitcnt lgkmcnt(7)
    v_mfma_f32_32x32x16_bf16 v[112:127], v[128:131], v[168:171], v[112:127]
    ds_read_b128 v[156:159], v3 offset:23552
    v_add_f32 v6, v6, v183
    v_fmac_f32 v7, v182, v182
    v_fmac_f32 v8, v183, v183
    s_waitcnt lgkmcnt(6)
    v_mfma_f32_32x32x16_bf16 v[16:31], v[132:135], v[172:175], v[16:31]
    s_barrier
    ds_read_b128 v[160:163], v11 offset:47104
    ds_read_b128 v[128:131], v3 offset:32768
    v_lshlrev_b32 v176, 16, v172
    v_and_b32 v177, s30, v172
    v_lshlrev_b32 v178, 16, v173
    v_and_b32 v179, s30, v173
    s_waitcnt lgkmcnt(7)
    v_mfma_f32_32x32x16_bf16 v[32:47], v[136:139], v[172:175], v[32:47]
    ds_read_b128 v[132:135], v3 offset:33792
    v_lshlrev_b32 v180, 16, v174
    v_and_b32 v181, s30, v174
    v_lshlrev_b32 v182, 16, v175
    v_and_b32 v183, s30, v175
    s_waitcnt lgkmcnt(7)
    v_mfma_f32_32x32x16_bf16 v[48:63], v[140:143], v[172:175], v[48:63]
    ds_read_b128 v[136:139], v3 offset:34816
    v_add_f32 v5, v5, v176
    v_add_f32 v6, v6, v177
    v_fmac_f32 v7, v176, v176
    v_fmac_f32 v8, v177, v177
    s_waitcnt lgkmcnt(7)
    v_mfma_f32_32x32x16_bf16 v[64:79], v[144:147], v[172:175], v[64:79]
    ds_read_b128 v[140:143], v3 offset:35840
    v_add_f32 v5, v5, v178
    v_add_f32 v6, v6, v179
    v_fmac_f32 v7, v178, v178
    s_waitcnt lgkmcnt(7)
    v_mfma_f32_32x32x16_bf16 v[80:95], v[148:151], v[172:175], v[80:95]
    ds_read_b128 v[144:147], v3 offset:36864
    v_fmac_f32 v8, v179, v179
    v_add_f32 v5, v5, v180
    v_add_f32 v6, v6, v181
    s_waitcnt lgkmcnt(7)
    v_mfma_f32_32x32x16_bf16 v[96:111], v[152:155], v[172:175], v[96:111]
    ds_read_b128 v[148:151], v3 offset:37888
    v_fmac_f32 v7, v180, v180
    v_fmac_f32 v8, v181, v181
    v_add_f32 v5, v5, v182
    s_waitcnt lgkmcnt(7)
    v_mfma_f32_32x32x16_bf16 v[112:127], v[156:159], v[172:175], v[112:127]
    ds_read_b128 v[152:155], v3 offset:38912
    v_add_f32 v6, v6, v183
    v_fmac_f32 v7, v182, v182
    v_fmac_f32 v8, v183, v183
    s_waitcnt lgkmcnt(6)
    v_mfma_f32_32x32x16_bf16 v[16:31], v[128:131], v[160:163], v[16:31]
    ds_read_b128 v[164:167], v11 offset:51200
    ds_read_b128 v[156:159], v3 offset:39936
    v_lshlrev_b32 v176, 16, v160
    v_and_b32 v177, s30, v160
    v_lshlrev_b32 v178, 16, v161
    v_and_b32 v179, s30, v161
    s_waitcnt lgkmcnt(7)
    v_mfma_f32_32x32x16_bf16 v[32:47], v[132:135], v[160:163], v[32:47]
    ds_read_b128 v[128:131], v3 offset:40960
    v_lshlrev_b32 v180, 16, v162
    v_and_b32 v181, s30, v162
    v_lshlrev_b32 v182, 16, v163
    v_and_b32 v183, s30, v163
    s_waitcnt lgkmcnt(7)
    v_mfma_f32_32x32x16_bf16 v[48:63], v[136:139], v[160:163], v[48:63]
    ds_read_b128 v[132:135], v3 offset:41984
    v_add_f32 v5, v5, v176
    v_add_f32 v6, v6, v177
    v_fmac_f32 v7, v176, v176
    v_fmac_f32 v8, v177, v177
    s_waitcnt lgkmcnt(7)
    v_mfma_f32_32x32x16_bf16 v[64:79], v[140:143], v[160:163], v[64:79]
    ds_read_b128 v[136:139], v3 offset:43008
    v_add_f32 v5, v5, v178
    v_add_f32 v6, v6, v179
    v_fmac_f32 v7, v178, v178
    s_waitcnt lgkmcnt(7)
    v_mfma_f32_32x32x16_bf16 v[80:95], v[144:147], v[160:163], v[80:95]
    ds_read_b128 v[140:143], v3 offset:44032
    v_fmac_f32 v8, v179, v179
    v_add_f32 v5, v5, v180
    v_add_f32 v6, v6, v181
    s_waitcnt lgkmcnt(7)
    v_mfma_f32_32x32x16_bf16 v[96:111], v[148:151], v[160:163], v[96:111]
    ds_read_b128 v[144:147], v3 offset:45056
    v_fmac_f32 v7, v180, v180
    v_fmac_f32 v8, v181, v181
    v_add_f32 v5, v5, v182
    s_waitcnt lgkmcnt(7)
    v_mfma_f32_32x32x16_bf16 v[112:127], v[152:155], v[160:163], v[112:127]
    ds_read_b128 v[148:151], v3 offset:46080
    v_add_f32 v6, v6, v183
    v_fmac_f32 v7, v182, v182
    v_fmac_f32 v8, v183, v183
    s_waitcnt lgkmcnt(6)
    v_mfma_f32_32x32x16_bf16 v[16:31], v[156:159], v[164:167], v[16:31]
    s_barrier
    ds_read_b128 v[168:171], v12 offset:12288
    ds_read_b128 v[152:155], v3 offset:55296
    v_lshlrev_b32 v176, 16, v164
    v_and_b32 v177, s30, v164
    v_lshlrev_b32 v178, 16, v165
    v_and_b32 v179, s30, v165
    s_waitcnt lgkmcnt(7)
    v_mfma_f32_32x32x16_bf16 v[32:47], v[128:131], v[164:167], v[32:47]
    ds_read_b128 v[156:159], v3 offset:56320
    v_lshlrev_b32 v180, 16, v166
    v_and_b32 v181, s30, v166
    v_lshlrev_b32 v182, 16, v167
    v_and_b32 v183, s30, v167
    s_waitcnt lgkmcnt(7)
    v_mfma_f32_32x32x16_bf16 v[48:63], v[132:135], v[164:167], v[48:63]
    ds_read_b128 v[128:131], v4 offset:0
    v_add_f32 v5, v5, v176
    v_add_f32 v6, v6, v177
    v_fmac_f32 v7, v176, v176
    v_fmac_f32 v8, v177, v177
    s_waitcnt lgkmcnt(7)
    v_mfma_f32_32x32x16_bf16 v[64:79], v[136:139], v[164:167], v[64:79]
    ds_read_b128 v[132:135], v4 offset:1024
    v_add_f32 v5, v5, v178
    v_add_f32 v6, v6, v179
    v_fmac_f32 v7, v178, v178
    s_waitcnt lgkmcnt(7)
    v_mfma_f32_32x32x16_bf16 v[80:95], v[140:143], v[164:167], v[80:95]
    ds_read_b128 v[136:139], v4 offset:2048
    v_fmac_f32 v8, v179, v179
    v_add_f32 v5, v5, v180
    v_add_f32 v6, v6, v181
    s_waitcnt lgkmcnt(7)
    v_mfma_f32_32x32x16_bf16 v[96:111], v[144:147], v[164:167], v[96:111]
    ds_read_b128 v[140:143], v4 offset:3072
    v_fmac_f32 v7, v180, v180
    v_fmac_f32 v8, v181, v181
    v_add_f32 v5, v5, v182
    s_waitcnt lgkmcnt(7)
    v_mfma_f32_32x32x16_bf16 v[112:127], v[148:151], v[164:167], v[112:127]
    ds_read_b128 v[144:147], v4 offset:4096
    v_add_f32 v6, v6, v183
    v_fmac_f32 v7, v182, v182
    v_fmac_f32 v8, v183, v183
    s_waitcnt lgkmcnt(6)
    v_mfma_f32_32x32x16_bf16 v[16:31], v[152:155], v[168:171], v[16:31]
    ds_read_b128 v[172:175], v12 offset:16384
    ds_read_b128 v[148:151], v4 offset:5120
    v_lshlrev_b32 v176, 16, v168
    v_and_b32 v177, s30, v168
    v_lshlrev_b32 v178, 16, v169
    v_and_b32 v179, s30, v169
    s_waitcnt lgkmcnt(7)
    v_mfma_f32_32x32x16_bf16 v[32:47], v[156:159], v[168:171], v[32:47]
    ds_read_b128 v[152:155], v4 offset:6144
    v_lshlrev_b32 v180, 16, v170
    v_and_b32 v181, s30, v170
    v_lshlrev_b32 v182, 16, v171
    v_and_b32 v183, s30, v171
    s_waitcnt lgkmcnt(7)
    v_mfma_f32_32x32x16_bf16 v[48:63], v[128:131], v[168:171], v[48:63]
    ds_read_b128 v[156:159], v4 offset:7168
    v_add_f32 v5, v5, v176
    v_add_f32 v6, v6, v177
    v_fmac_f32 v7, v176, v176
    v_fmac_f32 v8, v177, v177
    s_waitcnt lgkmcnt(7)
    v_mfma_f32_32x32x16_bf16 v[64:79], v[132:135], v[168:171], v[64:79]
    ds_read_b128 v[128:131], v4 offset:8192
    v_add_f32 v5, v5, v178
    v_add_f32 v6, v6, v179
    v_fmac_f32 v7, v178, v178
    s_waitcnt lgkmcnt(7)
    v_mfma_f32_32x32x16_bf16 v[80:95], v[136:139], v[168:171], v[80:95]
    ds_read_b128 v[132:135], v4 offset:9216
    v_fmac_f32 v8, v179, v179
    v_add_f32 v5, v5, v180
    v_add_f32 v6, v6, v181
    s_waitcnt lgkmcnt(7)
    v_mfma_f32_32x32x16_bf16 v[96:111], v[140:143], v[168:171], v[96:111]
    ds_read_b128 v[136:139], v4 offset:10240
    v_fmac_f32 v7, v180, v180
    v_fmac_f32 v8, v181, v181
    v_add_f32 v5, v5, v182
    s_waitcnt lgkmcnt(7)
    v_mfma_f32_32x32x16_bf16 v[112:127], v[144:147], v[168:171], v[112:127]
    ds_read_b128 v[140:143], v4 offset:11264
    v_add_f32 v6, v6, v183
    v_fmac_f32 v7, v182, v182
    v_fmac_f32 v8, v183, v183
    s_waitcnt lgkmcnt(6)
    v_mfma_f32_32x32x16_bf16 v[16:31], v[148:151], v[172:175], v[16:31]
    s_barrier
    ds_read_b128 v[160:163], v10 offset:14336
    ds_read_b128 v[144:147], v2 offset:0
    v_lshlrev_b32 v176, 16, v172
    v_and_b32 v177, s30, v172
    v_lshlrev_b32 v178, 16, v173
    v_and_b32 v179, s30, v173
    s_waitcnt lgkmcnt(7)
    v_mfma_f32_32x32x16_bf16 v[32:47], v[152:155], v[172:175], v[32:47]
    ds_read_b128 v[148:151], v2 offset:1024
    v_lshlrev_b32 v180, 16, v174
    v_and_b32 v181, s30, v174
    v_lshlrev_b32 v182, 16, v175
    v_and_b32 v183, s30, v175
    s_waitcnt lgkmcnt(7)
    v_mfma_f32_32x32x16_bf16 v[48:63], v[156:159], v[172:175], v[48:63]
    ds_read_b128 v[152:155], v2 offset:2048
    v_add_f32 v5, v5, v176
    v_add_f32 v6, v6, v177
    v_fmac_f32 v7, v176, v176
    v_fmac_f32 v8, v177, v177
    s_waitcnt lgkmcnt(7)
    v_mfma_f32_32x32x16_bf16 v[64:79], v[128:131], v[172:175], v[64:79]
    ds_read_b128 v[156:159], v2 offset:3072
    v_add_f32 v5, v5, v178
    v_add_f32 v6, v6, v179
    v_fmac_f32 v7, v178, v178
    s_waitcnt lgkmcnt(7)
    v_mfma_f32_32x32x16_bf16 v[80:95], v[132:135], v[172:175], v[80:95]
    ds_read_b128 v[128:131], v2 offset:4096
    v_fmac_f32 v8, v179, v179
    v_add_f32 v5, v5, v180
    v_add_f32 v6, v6, v181
    s_waitcnt lgkmcnt(7)
    v_mfma_f32_32x32x16_bf16 v[96:111], v[136:139], v[172:175], v[96:111]
    ds_read_b128 v[132:135], v2 offset:5120
    v_fmac_f32 v7, v180, v180
    v_fmac_f32 v8, v181, v181
    v_add_f32 v5, v5, v182
    s_waitcnt lgkmcnt(7)
    v_mfma_f32_32x32x16_bf16 v[112:127], v[140:143], v[172:175], v[112:127]
    ds_read_b128 v[136:139], v2 offset:6144
    v_add_f32 v6, v6, v183
    v_fmac_f32 v7, v182, v182
    v_fmac_f32 v8, v183, v183
    s_waitcnt lgkmcnt(6)
    v_mfma_f32_32x32x16_bf16 v[16:31], v[144:147], v[160:163], v[16:31]
    ds_read_b128 v[164:167], v10 offset:18432
    ds_read_b128 v[140:143], v2 offset:7168
    v_lshlrev_b32 v176, 16, v160
    v_and_b32 v177, s30, v160
    v_lshlrev_b32 v178, 16, v161
    v_and_b32 v179, s30, v161
    s_waitcnt lgkmcnt(7)
    v_mfma_f32_32x32x16_bf16 v[32:47], v[148:151], v[160:163], v[32:47]
    ds_read_b128 v[144:147], v2 offset:8192
    v_lshlrev_b32 v180, 16, v162
    v_and_b32 v181, s30, v162
    v_lshlrev_b32 v182, 16, v163
    v_and_b32 v183, s30, v163
    s_waitcnt lgkmcnt(7)
    v_mfma_f32_32x32x16_bf16 v[48:63], v[152:155], v[160:163], v[48:63]
    ds_read_b128 v[148:151], v2 offset:9216
    v_add_f32 v5, v5, v176
    v_add_f32 v6, v6, v177
    v_fmac_f32 v7, v176, v176
    v_fmac_f32 v8, v177, v177
    s_waitcnt lgkmcnt(7)
    v_mfma_f32_32x32x16_bf16 v[64:79], v[156:159], v[160:163], v[64:79]
    ds_read_b128 v[152:155], v2 offset:10240
    v_add_f32 v5, v5, v178
    v_add_f32 v6, v6, v179
    v_fmac_f32 v7, v178, v178
    s_waitcnt lgkmcnt(7)
    v_mfma_f32_32x32x16_bf16 v[80:95], v[128:131], v[160:163], v[80:95]
    ds_read_b128 v[156:159], v2 offset:11264
    v_fmac_f32 v8, v179, v179
    v_add_f32 v5, v5, v180
    v_add_f32 v6, v6, v181
    s_waitcnt lgkmcnt(7)
    v_mfma_f32_32x32x16_bf16 v[96:111], v[132:135], v[160:163], v[96:111]
    ds_read_b128 v[128:131], v2 offset:12288
    v_fmac_f32 v7, v180, v180
    v_fmac_f32 v8, v181, v181
    v_add_f32 v5, v5, v182
    s_waitcnt lgkmcnt(7)
    v_mfma_f32_32x32x16_bf16 v[112:127], v[136:139], v[160:163], v[112:127]
    ds_read_b128 v[132:135], v2 offset:13312
    v_add_f32 v6, v6, v183
    v_fmac_f32 v7, v182, v182
    v_fmac_f32 v8, v183, v183
    s_waitcnt lgkmcnt(6)
    v_mfma_f32_32x32x16_bf16 v[16:31], v[140:143], v[164:167], v[16:31]
    s_barrier
    ds_read_b128 v[168:171], v10 offset:36864
    ds_read_b128 v[136:139], v2 offset:22528
    v_lshlrev_b32 v176, 16, v164
    v_and_b32 v177, s30, v164
    v_lshlrev_b32 v178, 16, v165
    v_and_b32 v179, s30, v165
    s_waitcnt lgkmcnt(7)
    v_mfma_f32_32x32x16_bf16 v[32:47], v[144:147], v[164:167], v[32:47]
    ds_read_b128 v[140:143], v2 offset:23552
    v_lshlrev_b32 v180, 16, v166
    v_and_b32 v181, s30, v166
    v_lshlrev_b32 v182, 16, v167
    v_and_b32 v183, s30, v167
    s_waitcnt lgkmcnt(7)
    v_mfma_f32_32x32x16_bf16 v[48:63], v[148:151], v[164:167], v[48:63]
    ds_read_b128 v[144:147], v2 offset:24576
    v_add_f32 v5, v5, v176
    v_add_f32 v6, v6, v177
    v_fmac_f32 v7, v176, v176
    v_fmac_f32 v8, v177, v177
    s_waitcnt lgkmcnt(7)
    v_mfma_f32_32x32x16_bf16 v[64:79], v[152:155], v[164:167], v[64:79]
    ds_read_b128 v[148:151], v2 offset:25600
    v_add_f32 v5, v5, v178
    v_add_f32 v6, v6, v179
    v_fmac_f32 v7, v178, v178
    s_waitcnt lgkmcnt(7)
    v_mfma_f32_32x32x16_bf16 v[80:95], v[156:159], v[164:167], v[80:95]
    ds_read_b128 v[152:155], v2 offset:26624
    v_fmac_f32 v8, v179, v179
    v_add_f32 v5, v5, v180
    v_add_f32 v6, v6, v181
    s_waitcnt lgkmcnt(7)
    v_mfma_f32_32x32x16_bf16 v[96:111], v[128:131], v[164:167], v[96:111]
    ds_read_b128 v[156:159], v2 offset:27648
    v_fmac_f32 v7, v180, v180
    v_fmac_f32 v8, v181, v181
    v_add_f32 v5, v5, v182
    s_waitcnt lgkmcnt(7)
    v_mfma_f32_32x32x16_bf16 v[112:127], v[132:135], v[164:167], v[112:127]
    ds_read_b128 v[128:131], v2 offset:28672
    v_add_f32 v6, v6, v183
    v_fmac_f32 v7, v182, v182
    v_fmac_f32 v8, v183, v183
    s_waitcnt lgkmcnt(6)
    v_mfma_f32_32x32x16_bf16 v[16:31], v[136:139], v[168:171], v[16:31]
    ds_read_b128 v[172:175], v10 offset:40960
    ds_read_b128 v[132:135], v2 offset:29696
    v_lshlrev_b32 v176, 16, v168
    v_and_b32 v177, s30, v168
    v_lshlrev_b32 v178, 16, v169
    v_and_b32 v179, s30, v169
    s_waitcnt lgkmcnt(7)
    v_mfma_f32_32x32x16_bf16 v[32:47], v[140:143], v[168:171], v[32:47]
    ds_read_b128 v[136:139], v2 offset:30720
    v_lshlrev_b32 v180, 16, v170
    v_and_b32 v181, s30, v170
    v_lshlrev_b32 v182, 16, v171
    v_and_b32 v183, s30, v171
    s_waitcnt lgkmcnt(7)
    v_mfma_f32_32x32x16_bf16 v[48:63], v[144:147], v[168:171], v[48:63]
    ds_read_b128 v[140:143], v2 offset:31744
    v_add_f32 v5, v5, v176
    v_add_f32 v6, v6, v177
    v_fmac_f32 v7, v176, v176
    v_fmac_f32 v8, v177, v177
    s_waitcnt lgkmcnt(7)
    v_mfma_f32_32x32x16_bf16 v[64:79], v[148:151], v[168:171], v[64:79]
    ds_read_b128 v[144:147], v2 offset:32768
    v_add_f32 v5, v5, v178
    v_add_f32 v6, v6, v179
    v_fmac_f32 v7, v178, v178
    s_waitcnt lgkmcnt(7)
    v_mfma_f32_32x32x16_bf16 v[80:95], v[152:155], v[168:171], v[80:95]
    ds_read_b128 v[148:151], v2 offset:33792
    v_fmac_f32 v8, v179, v179
    v_add_f32 v5, v5, v180
    v_add_f32 v6, v6, v181
    s_waitcnt lgkmcnt(7)
    v_mfma_f32_32x32x16_bf16 v[96:111], v[156:159], v[168:171], v[96:111]
    ds_read_b128 v[152:155], v2 offset:34816
    v_fmac_f32 v7, v180, v180
    v_fmac_f32 v8, v181, v181
    v_add_f32 v5, v5, v182
    s_waitcnt lgkmcnt(7)
    v_mfma_f32_32x32x16_bf16 v[112:127], v[128:131], v[168:171], v[112:127]
    ds_read_b128 v[156:159], v2 offset:35840
    v_add_f32 v6, v6, v183
    v_fmac_f32 v7, v182, v182
    v_fmac_f32 v8, v183, v183
    s_waitcnt lgkmcnt(6)
    v_mfma_f32_32x32x16_bf16 v[16:31], v[132:135], v[172:175], v[16:31]
    s_barrier
    ds_read_b128 v[160:163], v11 offset:2048
    ds_read_b128 v[128:131], v2 offset:45056
    v_lshlrev_b32 v176, 16, v172
    v_and_b32 v177, s30, v172
    v_lshlrev_b32 v178, 16, v173
    v_and_b32 v179, s30, v173
    s_waitcnt lgkmcnt(7)
    v_mfma_f32_32x32x16_bf16 v[32:47], v[136:139], v[172:175], v[32:47]
    ds_read_b128 v[132:135], v2 offset:46080
    v_lshlrev_b32 v180, 16, v174
    v_and_b32 v181, s30, v174
    v_lshlrev_b32 v182, 16, v175
    v_and_b32 v183, s30, v175
    s_waitcnt lgkmcnt(7)
    v_mfma_f32_32x32x16_bf16 v[48:63], v[140:143], v[172:175], v[48:63]
    ds_read_b128 v[136:139], v2 offset:47104
    v_add_f32 v5, v5, v176
    v_add_f32 v6, v6, v177
    v_fmac_f32 v7, v176, v176
    v_fmac_f32 v8, v177, v177
    s_waitcnt lgkmcnt(7)
    v_mfma_f32_32x32x16_bf16 v[64:79], v[144:147], v[172:175], v[64:79]
    ds_read_b128 v[140:143], v2 offset:48128
    v_add_f32 v5, v5, v178
    v_add_f32 v6, v6, v179
    v_fmac_f32 v7, v178, v178
    s_waitcnt lgkmcnt(7)
    v_mfma_f32_32x32x16_bf16 v[80:95], v[148:151], v[172:175], v[80:95]
    ds_read_b128 v[144:147], v2 offset:49152
    v_fmac_f32 v8, v179, v179
    v_add_f32 v5, v5, v180
    v_add_f32 v6, v6, v181
    s_waitcnt lgkmcnt(7)
    v_mfma_f32_32x32x16_bf16 v[96:111], v[152:155], v[172:175], v[96:111]
    ds_read_b128 v[148:151], v2 offset:50176
    v_fmac_f32 v7, v180, v180
    v_fmac_f32 v8, v181, v181
    v_add_f32 v5, v5, v182
    s_waitcnt lgkmcnt(7)
    v_mfma_f32_32x32x16_bf16 v[112:127], v[156:159], v[172:175], v[112:127]
    ds_read_b128 v[152:155], v2 offset:51200
    v_add_f32 v6, v6, v183
    v_fmac_f32 v7, v182, v182
    v_fmac_f32 v8, v183, v183
    s_waitcnt lgkmcnt(6)
    v_mfma_f32_32x32x16_bf16 v[16:31], v[128:131], v[160:163], v[16:31]
    ds_read_b128 v[164:167], v11 offset:6144
    ds_read_b128 v[156:159], v2 offset:52224
    v_lshlrev_b32 v176, 16, v160
    v_and_b32 v177, s30, v160
    v_lshlrev_b32 v178, 16, v161
    v_and_b32 v179, s30, v161
    s_waitcnt lgkmcnt(7)
    v_mfma_f32_32x32x16_bf16 v[32:47], v[132:135], v[160:163], v[32:47]
    ds_read_b128 v[128:131], v2 offset:53248
    v_lshlrev_b32 v180, 16, v162
    v_and_b32 v181, s30, v162
    v_lshlrev_b32 v182, 16, v163
    v_and_b32 v183, s30, v163
    s_waitcnt lgkmcnt(7)
    v_mfma_f32_32x32x16_bf16 v[48:63], v[136:139], v[160:163], v[48:63]
    ds_read_b128 v[132:135], v2 offset:54272
    v_add_f32 v5, v5, v176
    v_add_f32 v6, v6, v177
    v_fmac_f32 v7, v176, v176
    v_fmac_f32 v8, v177, v177
    s_waitcnt lgkmcnt(7)
    v_mfma_f32_32x32x16_bf16 v[64:79], v[140:143], v[160:163], v[64:79]
    ds_read_b128 v[136:139], v2 offset:55296
    v_add_f32 v5, v5, v178
    v_add_f32 v6, v6, v179
    v_fmac_f32 v7, v178, v178
    s_waitcnt lgkmcnt(7)
    v_mfma_f32_32x32x16_bf16 v[80:95], v[144:147], v[160:163], v[80:95]
    ds_read_b128 v[140:143], v2 offset:56320
    v_fmac_f32 v8, v179, v179
    v_add_f32 v5, v5, v180
    v_add_f32 v6, v6, v181
    s_waitcnt lgkmcnt(7)
    v_mfma_f32_32x32x16_bf16 v[96:111], v[148:151], v[160:163], v[96:111]
    ds_read_b128 v[144:147], v3 offset:0
    v_fmac_f32 v7, v180, v180
    v_fmac_f32 v8, v181, v181
    v_add_f32 v5, v5, v182
    s_waitcnt lgkmcnt(7)
    v_mfma_f32_32x32x16_bf16 v[112:127], v[152:155], v[160:163], v[112:127]
    ds_read_b128 v[148:151], v3 offset:1024
    v_add_f32 v6, v6, v183
    v_fmac_f32 v7, v182, v182
    v_fmac_f32 v8, v183, v183
    s_waitcnt lgkmcnt(6)
    v_mfma_f32_32x32x16_bf16 v[16:31], v[156:159], v[164:167], v[16:31]
    s_barrier
    ds_read_b128 v[168:171], v11 offset:24576
    ds_read_b128 v[152:155], v3 offset:10240
    v_lshlrev_b32 v176, 16, v164
    v_and_b32 v177, s30, v164
    v_lshlrev_b32 v178, 16, v165
    v_and_b32 v179, s30, v165
    s_waitcnt lgkmcnt(7)
    v_mfma_f32_32x32x16_bf16 v[32:47], v[128:131], v[164:167], v[32:47]
    ds_read_b128 v[156:159], v3 offset:11264
    v_lshlrev_b32 v180, 16, v166
    v_and_b32 v181, s30, v166
    v_lshlrev_b32 v182, 16, v167
    v_and_b32 v183, s30, v167
    s_waitcnt lgkmcnt(7)
    v_mfma_f32_32x32x16_bf16 v[48:63], v[132:135], v[164:167], v[48:63]
    ds_read_b128 v[128:131], v3 offset:12288
    v_add_f32 v5, v5, v176
    v_add_f32 v6, v6, v177
    v_fmac_f32 v7, v176, v176
    v_fmac_f32 v8, v177, v177
    s_waitcnt lgkmcnt(7)
    v_mfma_f32_32x32x16_bf16 v[64:79], v[136:139], v[164:167], v[64:79]
    ds_read_b128 v[132:135], v3 offset:13312
    v_add_f32 v5, v5, v178
    v_add_f32 v6, v6, v179
    v_fmac_f32 v7, v178, v178
    s_waitcnt lgkmcnt(7)
    v_mfma_f32_32x32x16_bf16 v[80:95], v[140:143], v[164:167], v[80:95]
    ds_read_b128 v[136:139], v3 offset:14336
    v_fmac_f32 v8, v179, v179
    v_add_f32 v5, v5, v180
    v_add_f32 v6, v6, v181
    s_waitcnt lgkmcnt(7)
    v_mfma_f32_32x32x16_bf16 v[96:111], v[144:147], v[164:167], v[96:111]
    ds_read_b128 v[140:143], v3 offset:15360
    v_fmac_f32 v7, v180, v180
    v_fmac_f32 v8, v181, v181
    v_add_f32 v5, v5, v182
    s_waitcnt lgkmcnt(7)
    v_mfma_f32_32x32x16_bf16 v[112:127], v[148:151], v[164:167], v[112:127]
    ds_read_b128 v[144:147], v3 offset:16384
    v_add_f32 v6, v6, v183
    v_fmac_f32 v7, v182, v182
    v_fmac_f32 v8, v183, v183
    s_waitcnt lgkmcnt(6)
    v_mfma_f32_32x32x16_bf16 v[16:31], v[152:155], v[168:171], v[16:31]
    ds_read_b128 v[172:175], v11 offset:28672
    ds_read_b128 v[148:151], v3 offset:17408
    v_lshlrev_b32 v176, 16, v168
    v_and_b32 v177, s30, v168
    v_lshlrev_b32 v178, 16, v169
    v_and_b32 v179, s30, v169
    s_waitcnt lgkmcnt(7)
    v_mfma_f32_32x32x16_bf16 v[32:47], v[156:159], v[168:171], v[32:47]
    ds_read_b128 v[152:155], v3 offset:18432
    v_lshlrev_b32 v180, 16, v170
    v_and_b32 v181, s30, v170
    v_lshlrev_b32 v182, 16, v171
    v_and_b32 v183, s30, v171
    s_waitcnt lgkmcnt(7)
    v_mfma_f32_32x32x16_bf16 v[48:63], v[128:131], v[168:171], v[48:63]
    ds_read_b128 v[156:159], v3 offset:19456
    v_add_f32 v5, v5, v176
    v_add_f32 v6, v6, v177
    v_fmac_f32 v7, v176, v176
    v_fmac_f32 v8, v177, v177
    s_waitcnt lgkmcnt(7)
    v_mfma_f32_32x32x16_bf16 v[64:79], v[132:135], v[168:171], v[64:79]
    ds_read_b128 v[128:131], v3 offset:20480
    v_add_f32 v5, v5, v178
    v_add_f32 v6, v6, v179
    v_fmac_f32 v7, v178, v178
    s_waitcnt lgkmcnt(7)
    v_mfma_f32_32x32x16_bf16 v[80:95], v[136:139], v[168:171], v[80:95]
    ds_read_b128 v[132:135], v3 offset:21504
    v_fmac_f32 v8, v179, v179
    v_add_f32 v5, v5, v180
    v_add_f32 v6, v6, v181
    s_waitcnt lgkmcnt(7)
    v_mfma_f32_32x32x16_bf16 v[96:111], v[140:143], v[168:171], v[96:111]
    ds_read_b128 v[136:139], v3 offset:22528
    v_fmac_f32 v7, v180, v180
    v_fmac_f32 v8, v181, v181
    v_add_f32 v5, v5, v182
    s_waitcnt lgkmcnt(7)
    v_mfma_f32_32x32x16_bf16 v[112:127], v[144:147], v[168:171], v[112:127]
    ds_read_b128 v[140:143], v3 offset:23552
    v_add_f32 v6, v6, v183
    v_fmac_f32 v7, v182, v182
    v_fmac_f32 v8, v183, v183
    s_waitcnt lgkmcnt(6)
    v_mfma_f32_32x32x16_bf16 v[16:31], v[148:151], v[172:175], v[16:31]
    s_barrier
    ds_read_b128 v[160:163], v11 offset:47104
    ds_read_b128 v[144:147], v3 offset:32768
    v_lshlrev_b32 v176, 16, v172
    v_and_b32 v177, s30, v172
    v_lshlrev_b32 v178, 16, v173
    v_and_b32 v179, s30, v173
    s_waitcnt lgkmcnt(7)
    v_mfma_f32_32x32x16_bf16 v[32:47], v[152:155], v[172:175], v[32:47]
    ds_read_b128 v[148:151], v3 offset:33792
    v_lshlrev_b32 v180, 16, v174
    v_and_b32 v181, s30, v174
    v_lshlrev_b32 v182, 16, v175
    v_and_b32 v183, s30, v175
    s_waitcnt lgkmcnt(7)
    v_mfma_f32_32x32x16_bf16 v[48:63], v[156:159], v[172:175], v[48:63]
    ds_read_b128 v[152:155], v3 offset:34816
    v_add_f32 v5, v5, v176
    v_add_f32 v6, v6, v177
    v_fmac_f32 v7, v176, v176
    v_fmac_f32 v8, v177, v177
    s_waitcnt lgkmcnt(7)
    v_mfma_f32_32x32x16_bf16 v[64:79], v[128:131], v[172:175], v[64:79]
    ds_read_b128 v[156:159], v3 offset:35840
    v_add_f32 v5, v5, v178
    v_add_f32 v6, v6, v179
    v_fmac_f32 v7, v178, v178
    s_waitcnt lgkmcnt(7)
    v_mfma_f32_32x32x16_bf16 v[80:95], v[132:135], v[172:175], v[80:95]
    ds_read_b128 v[128:131], v3 offset:36864
    v_fmac_f32 v8, v179, v179
    v_add_f32 v5, v5, v180
    v_add_f32 v6, v6, v181
    s_waitcnt lgkmcnt(7)
    v_mfma_f32_32x32x16_bf16 v[96:111], v[136:139], v[172:175], v[96:111]
    ds_read_b128 v[132:135], v3 offset:37888
    v_fmac_f32 v7, v180, v180
    v_fmac_f32 v8, v181, v181
    v_add_f32 v5, v5, v182
    s_waitcnt lgkmcnt(7)
    v_mfma_f32_32x32x16_bf16 v[112:127], v[140:143], v[172:175], v[112:127]
    ds_read_b128 v[136:139], v3 offset:38912
    v_add_f32 v6, v6, v183
    v_fmac_f32 v7, v182, v182
    v_fmac_f32 v8, v183, v183
    s_waitcnt lgkmcnt(6)
    v_mfma_f32_32x32x16_bf16 v[16:31], v[144:147], v[160:163], v[16:31]
    ds_read_b128 v[164:167], v11 offset:51200
    ds_read_b128 v[140:143], v3 offset:39936
    v_lshlrev_b32 v176, 16, v160
    v_and_b32 v177, s30, v160
    v_lshlrev_b32 v178, 16, v161
    v_and_b32 v179, s30, v161
    s_waitcnt lgkmcnt(7)
    v_mfma_f32_32x32x16_bf16 v[32:47], v[148:151], v[160:163], v[32:47]
    ds_read_b128 v[144:147], v3 offset:40960
    v_lshlrev_b32 v180, 16, v162
    v_and_b32 v181, s30, v162
    v_lshlrev_b32 v182, 16, v163
    v_and_b32 v183, s30, v163
    s_waitcnt lgkmcnt(7)
    v_mfma_f32_32x32x16_bf16 v[48:63], v[152:155], v[160:163], v[48:63]
    ds_read_b128 v[148:151], v3 offset:41984
    v_add_f32 v5, v5, v176
    v_add_f32 v6, v6, v177
    v_fmac_f32 v7, v176, v176
    v_fmac_f32 v8, v177, v177
    s_waitcnt lgkmcnt(7)
    v_mfma_f32_32x32x16_bf16 v[64:79], v[156:159], v[160:163], v[64:79]
    ds_read_b128 v[152:155], v3 offset:43008
    v_add_f32 v5, v5, v178
    v_add_f32 v6, v6, v179
    v_fmac_f32 v7, v178, v178
    s_waitcnt lgkmcnt(7)
    v_mfma_f32_32x32x16_bf16 v[80:95], v[128:131], v[160:163], v[80:95]
    ds_read_b128 v[156:159], v3 offset:44032
    v_fmac_f32 v8, v179, v179
    v_add_f32 v5, v5, v180
    v_add_f32 v6, v6, v181
    s_waitcnt lgkmcnt(7)
    v_mfma_f32_32x32x16_bf16 v[96:111], v[132:135], v[160:163], v[96:111]
    ds_read_b128 v[128:131], v3 offset:45056
    v_fmac_f32 v7, v180, v180
    v_fmac_f32 v8, v181, v181
    v_add_f32 v5, v5, v182
    s_waitcnt lgkmcnt(7)
    v_mfma_f32_32x32x16_bf16 v[112:127], v[136:139], v[160:163], v[112:127]
    ds_read_b128 v[132:135], v3 offset:46080
    v_add_f32 v6, v6, v183
    v_fmac_f32 v7, v182, v182
    v_fmac_f32 v8, v183, v183
    s_waitcnt lgkmcnt(6)
    v_mfma_f32_32x32x16_bf16 v[16:31], v[140:143], v[164:167], v[16:31]
    s_barrier
    ds_read_b128 v[168:171], v12 offset:12288
    ds_read_b128 v[136:139], v3 offset:55296
    v_lshlrev_b32 v176, 16, v164
    v_and_b32 v177, s30, v164
    v_lshlrev_b32 v178, 16, v165
    v_and_b32 v179, s30, v165
    s_waitcnt lgkmcnt(7)
    v_mfma_f32_32x32x16_bf16 v[32:47], v[144:147], v[164:167], v[32:47]
    ds_read_b128 v[140:143], v3 offset:56320
    v_lshlrev_b32 v180, 16, v166
    v_and_b32 v181, s30, v166
    v_lshlrev_b32 v182, 16, v167
    v_and_b32 v183, s30, v167
    s_waitcnt lgkmcnt(7)
    v_mfma_f32_32x32x16_bf16 v[48:63], v[148:151], v[164:167], v[48:63]
    ds_read_b128 v[144:147], v4 offset:0
    v_add_f32 v5, v5, v176
    v_add_f32 v6, v6, v177
    v_fmac_f32 v7, v176, v176
    v_fmac_f32 v8, v177, v177
    s_waitcnt lgkmcnt(7)
    v_mfma_f32_32x32x16_bf16 v[64:79], v[152:155], v[164:167], v[64:79]
    ds_read_b128 v[148:151], v4 offset:1024
    v_add_f32 v5, v5, v178
    v_add_f32 v6, v6, v179
    v_fmac_f32 v7, v178, v178
    s_waitcnt lgkmcnt(7)
    v_mfma_f32_32x32x16_bf16 v[80:95], v[156:159], v[164:167], v[80:95]
    ds_read_b128 v[152:155], v4 offset:2048
    v_fmac_f32 v8, v179, v179
    v_add_f32 v5, v5, v180
    v_add_f32 v6, v6, v181
    s_waitcnt lgkmcnt(7)
    v_mfma_f32_32x32x16_bf16 v[96:111], v[128:131], v[164:167], v[96:111]
    ds_read_b128 v[156:159], v4 offset:3072
    v_fmac_f32 v7, v180, v180
    v_fmac_f32 v8, v181, v181
    v_add_f32 v5, v5, v182
    s_waitcnt lgkmcnt(7)
    v_mfma_f32_32x32x16_bf16 v[112:127], v[132:135], v[164:167], v[112:127]
    ds_read_b128 v[128:131], v4 offset:4096
    v_add_f32 v6, v6, v183
    v_fmac_f32 v7, v182, v182
    v_fmac_f32 v8, v183, v183
    s_waitcnt lgkmcnt(6)
    v_mfma_f32_32x32x16_bf16 v[16:31], v[136:139], v[168:171], v[16:31]
    ds_read_b128 v[172:175], v12 offset:16384
    ds_read_b128 v[132:135], v4 offset:5120
    v_lshlrev_b32 v176, 16, v168
    v_and_b32 v177, s30, v168
    v_lshlrev_b32 v178, 16, v169
    v_and_b32 v179, s30, v169
    s_waitcnt lgkmcnt(7)
    v_mfma_f32_32x32x16_bf16 v[32:47], v[140:143], v[168:171], v[32:47]
    ds_read_b128 v[136:139], v4 offset:6144
    v_lshlrev_b32 v180, 16, v170
    v_and_b32 v181, s30, v170
    v_lshlrev_b32 v182, 16, v171
    v_and_b32 v183, s30, v171
    s_waitcnt lgkmcnt(7)
    v_mfma_f32_32x32x16_bf16 v[48:63], v[144:147], v[168:171], v[48:63]
    ds_read_b128 v[140:143], v4 offset:7168
    v_add_f32 v5, v5, v176
    v_add_f32 v6, v6, v177
    v_fmac_f32 v7, v176, v176
    v_fmac_f32 v8, v177, v177
    s_waitcnt lgkmcnt(7)
    v_mfma_f32_32x32x16_bf16 v[64:79], v[148:151], v[168:171], v[64:79]
    ds_read_b128 v[144:147], v4 offset:8192
    v_add_f32 v5, v5, v178
    v_add_f32 v6, v6, v179
    v_fmac_f32 v7, v178, v178
    s_waitcnt lgkmcnt(7)
    v_mfma_f32_32x32x16_bf16 v[80:95], v[152:155], v[168:171], v[80:95]
    ds_read_b128 v[148:151], v4 offset:9216
    v_fmac_f32 v8, v179, v179
    v_add_f32 v5, v5, v180
    v_add_f32 v6, v6, v181
    s_waitcnt lgkmcnt(7)
    v_mfma_f32_32x32x16_bf16 v[96:111], v[156:159], v[168:171], v[96:111]
    ds_read_b128 v[152:155], v4 offset:10240
    v_fmac_f32 v7, v180, v180
    v_fmac_f32 v8, v181, v181
    v_add_f32 v5, v5, v182
    s_waitcnt lgkmcnt(7)
    v_mfma_f32_32x32x16_bf16 v[112:127], v[128:131], v[168:171], v[112:127]
    ds_read_b128 v[156:159], v4 offset:11264
    v_add_f32 v6, v6, v183
    v_fmac_f32 v7, v182, v182
    v_fmac_f32 v8, v183, v183
    s_waitcnt lgkmcnt(6)
    v_mfma_f32_32x32x16_bf16 v[16:31], v[132:135], v[172:175], v[16:31]
    s_barrier
    ds_read_b128 v[160:163], v10 offset:14336
    ds_read_b128 v[128:131], v2 offset:0
    v_lshlrev_b32 v176, 16, v172
    v_and_b32 v177, s30, v172
    v_lshlrev_b32 v178, 16, v173
    v_and_b32 v179, s30, v173
    s_waitcnt lgkmcnt(7)
    v_mfma_f32_32x32x16_bf16 v[32:47], v[136:139], v[172:175], v[32:47]
    ds_read_b128 v[132:135], v2 offset:1024
    v_lshlrev_b32 v180, 16, v174
    v_and_b32 v181, s30, v174
    v_lshlrev_b32 v182, 16, v175
    v_and_b32 v183, s30, v175
    s_waitcnt lgkmcnt(7)
    v_mfma_f32_32x32x16_bf16 v[48:63], v[140:143], v[172:175], v[48:63]
    ds_read_b128 v[136:139], v2 offset:2048
    v_add_f32 v5, v5, v176
    v_add_f32 v6, v6, v177
    v_fmac_f32 v7, v176, v176
    v_fmac_f32 v8, v177, v177
    s_waitcnt lgkmcnt(7)
    v_mfma_f32_32x32x16_bf16 v[64:79], v[144:147], v[172:175], v[64:79]
    ds_read_b128 v[140:143], v2 offset:3072
    v_add_f32 v5, v5, v178
    v_add_f32 v6, v6, v179
    v_fmac_f32 v7, v178, v178
    s_waitcnt lgkmcnt(7)
    v_mfma_f32_32x32x16_bf16 v[80:95], v[148:151], v[172:175], v[80:95]
    ds_read_b128 v[144:147], v2 offset:4096
    v_fmac_f32 v8, v179, v179
    v_add_f32 v5, v5, v180
    v_add_f32 v6, v6, v181
    s_waitcnt lgkmcnt(7)
    v_mfma_f32_32x32x16_bf16 v[96:111], v[152:155], v[172:175], v[96:111]
    ds_read_b128 v[148:151], v2 offset:5120
    v_fmac_f32 v7, v180, v180
    v_fmac_f32 v8, v181, v181
    v_add_f32 v5, v5, v182
    s_waitcnt lgkmcnt(7)
    v_mfma_f32_32x32x16_bf16 v[112:127], v[156:159], v[172:175], v[112:127]
    ds_read_b128 v[152:155], v2 offset:6144
    v_add_f32 v6, v6, v183
    v_fmac_f32 v7, v182, v182
    v_fmac_f32 v8, v183, v183
    s_waitcnt lgkmcnt(6)
    v_mfma_f32_32x32x16_bf16 v[16:31], v[128:131], v[160:163], v[16:31]
    ds_read_b128 v[164:167], v10 offset:18432
    ds_read_b128 v[156:159], v2 offset:7168
    v_lshlrev_b32 v176, 16, v160
    v_and_b32 v177, s30, v160
    v_lshlrev_b32 v178, 16, v161
    v_and_b32 v179, s30, v161
    s_waitcnt lgkmcnt(7)
    v_mfma_f32_32x32x16_bf16 v[32:47], v[132:135], v[160:163], v[32:47]
    ds_read_b128 v[128:131], v2 offset:8192
    v_lshlrev_b32 v180, 16, v162
    v_and_b32 v181, s30, v162
    v_lshlrev_b32 v182, 16, v163
    v_and_b32 v183, s30, v163
    s_waitcnt lgkmcnt(7)
    v_mfma_f32_32x32x16_bf16 v[48:63], v[136:139], v[160:163], v[48:63]
    ds_read_b128 v[132:135], v2 offset:9216
    v_add_f32 v5, v5, v176
    v_add_f32 v6, v6, v177
    v_fmac_f32 v7, v176, v176
    v_fmac_f32 v8, v177, v177
    s_waitcnt lgkmcnt(7)
    v_mfma_f32_32x32x16_bf16 v[64:79], v[140:143], v[160:163], v[64:79]
    ds_read_b128 v[136:139], v2 offset:10240
    v_add_f32 v5, v5, v178
    v_add_f32 v6, v6, v179
    v_fmac_f32 v7, v178, v178
    s_waitcnt lgkmcnt(7)
    v_mfma_f32_32x32x16_bf16 v[80:95], v[144:147], v[160:163], v[80:95]
    ds_read_b128 v[140:143], v2 offset:11264
    v_fmac_f32 v8, v179, v179
    v_add_f32 v5, v5, v180
    v_add_f32 v6, v6, v181
    s_waitcnt lgkmcnt(7)
    v_mfma_f32_32x32x16_bf16 v[96:111], v[148:151], v[160:163], v[96:111]
    ds_read_b128 v[144:147], v2 offset:12288
    v_fmac_f32 v7, v180, v180
    v_fmac_f32 v8, v181, v181
    v_add_f32 v5, v5, v182
    s_waitcnt lgkmcnt(7)
    v_mfma_f32_32x32x16_bf16 v[112:127], v[152:155], v[160:163], v[112:127]
    ds_read_b128 v[148:151], v2 offset:13312
    v_add_f32 v6, v6, v183
    v_fmac_f32 v7, v182, v182
    v_fmac_f32 v8, v183, v183
    s_waitcnt lgkmcnt(6)
    v_mfma_f32_32x32x16_bf16 v[16:31], v[156:159], v[164:167], v[16:31]
    s_barrier
    ds_read_b128 v[168:171], v10 offset:36864
    ds_read_b128 v[152:155], v2 offset:22528
    v_lshlrev_b32 v176, 16, v164
    v_and_b32 v177, s30, v164
    v_lshlrev_b32 v178, 16, v165
    v_and_b32 v179, s30, v165
    s_waitcnt lgkmcnt(7)
    v_mfma_f32_32x32x16_bf16 v[32:47], v[128:131], v[164:167], v[32:47]
    ds_read_b128 v[156:159], v2 offset:23552
    v_lshlrev_b32 v180, 16, v166
    v_and_b32 v181, s30, v166
    v_lshlrev_b32 v182, 16, v167
    v_and_b32 v183, s30, v167
    s_waitcnt lgkmcnt(7)
    v_mfma_f32_32x32x16_bf16 v[48:63], v[132:135], v[164:167], v[48:63]
    ds_read_b128 v[128:131], v2 offset:24576
    v_add_f32 v5, v5, v176
    v_add_f32 v6, v6, v177
    v_fmac_f32 v7, v176, v176
    v_fmac_f32 v8, v177, v177
    s_waitcnt lgkmcnt(7)
    v_mfma_f32_32x32x16_bf16 v[64:79], v[136:139], v[164:167], v[64:79]
    ds_read_b128 v[132:135], v2 offset:25600
    v_add_f32 v5, v5, v178
    v_add_f32 v6, v6, v179
    v_fmac_f32 v7, v178, v178
    s_waitcnt lgkmcnt(7)
    v_mfma_f32_32x32x16_bf16 v[80:95], v[140:143], v[164:167], v[80:95]
    ds_read_b128 v[136:139], v2 offset:26624
    v_fmac_f32 v8, v179, v179
    v_add_f32 v5, v5, v180
    v_add_f32 v6, v6, v181
    s_waitcnt lgkmcnt(7)
    v_mfma_f32_32x32x16_bf16 v[96:111], v[144:147], v[164:167], v[96:111]
    ds_read_b128 v[140:143], v2 offset:27648
    v_fmac_f32 v7, v180, v180
    v_fmac_f32 v8, v181, v181
    v_add_f32 v5, v5, v182
    s_waitcnt lgkmcnt(7)
    v_mfma_f32_32x32x16_bf16 v[112:127], v[148:151], v[164:167], v[112:127]
    ds_read_b128 v[144:147], v2 offset:28672
    v_add_f32 v6, v6, v183
    v_fmac_f32 v7, v182, v182
    v_fmac_f32 v8, v183, v183
    s_waitcnt lgkmcnt(6)
    v_mfma_f32_32x32x16_bf16 v[16:31], v[152:155], v[168:171], v[16:31]
    ds_read_b128 v[172:175], v10 offset:40960
    ds_read_b128 v[148:151], v2 offset:29696
    v_lshlrev_b32 v176, 16, v168
    v_and_b32 v177, s30, v168
    v_lshlrev_b32 v178, 16, v169
    v_and_b32 v179, s30, v169
    s_waitcnt lgkmcnt(7)
    v_mfma_f32_32x32x16_bf16 v[32:47], v[156:159], v[168:171], v[32:47]
    ds_read_b128 v[152:155], v2 offset:30720
    v_lshlrev_b32 v180, 16, v170
    v_and_b32 v181, s30, v170
    v_lshlrev_b32 v182, 16, v171
    v_and_b32 v183, s30, v171
    s_waitcnt lgkmcnt(7)
    v_mfma_f32_32x32x16_bf16 v[48:63], v[128:131], v[168:171], v[48:63]
    ds_read_b128 v[156:159], v2 offset:31744
    v_add_f32 v5, v5, v176
    v_add_f32 v6, v6, v177
    v_fmac_f32 v7, v176, v176
    v_fmac_f32 v8, v177, v177
    s_waitcnt lgkmcnt(7)
    v_mfma_f32_32x32x16_bf16 v[64:79], v[132:135], v[168:171], v[64:79]
    ds_read_b128 v[128:131], v2 offset:32768
    v_add_f32 v5, v5, v178
    v_add_f32 v6, v6, v179
    v_fmac_f32 v7, v178, v178
    s_waitcnt lgkmcnt(7)
    v_mfma_f32_32x32x16_bf16 v[80:95], v[136:139], v[168:171], v[80:95]
    ds_read_b128 v[132:135], v2 offset:33792
    v_fmac_f32 v8, v179, v179
    v_add_f32 v5, v5, v180
    v_add_f32 v6, v6, v181
    s_waitcnt lgkmcnt(7)
    v_mfma_f32_32x32x16_bf16 v[96:111], v[140:143], v[168:171], v[96:111]
    ds_read_b128 v[136:139], v2 offset:34816
    v_fmac_f32 v7, v180, v180
    v_fmac_f32 v8, v181, v181
    v_add_f32 v5, v5, v182
    s_waitcnt lgkmcnt(7)
    v_mfma_f32_32x32x16_bf16 v[112:127], v[144:147], v[168:171], v[112:127]
    ds_read_b128 v[140:143], v2 offset:35840
    v_add_f32 v6, v6, v183
    v_fmac_f32 v7, v182, v182
    v_fmac_f32 v8, v183, v183
    s_waitcnt lgkmcnt(6)
    v_mfma_f32_32x32x16_bf16 v[16:31], v[148:151], v[172:175], v[16:31]
    s_barrier
    ds_read_b128 v[160:163], v11 offset:2048
    ds_read_b128 v[144:147], v2 offset:45056
    v_lshlrev_b32 v176, 16, v172
    v_and_b32 v177, s30, v172
    v_lshlrev_b32 v178, 16, v173
    v_and_b32 v179, s30, v173
    s_waitcnt lgkmcnt(7)
    v_mfma_f32_32x32x16_bf16 v[32:47], v[152:155], v[172:175], v[32:47]
    ds_read_b128 v[148:151], v2 offset:46080
    v_lshlrev_b32 v180, 16, v174
    v_and_b32 v181, s30, v174
    v_lshlrev_b32 v182, 16, v175
    v_and_b32 v183, s30, v175
    s_waitcnt lgkmcnt(7)
    v_mfma_f32_32x32x16_bf16 v[48:63], v[156:159], v[172:175], v[48:63]
    ds_read_b128 v[152:155], v2 offset:47104
    v_add_f32 v5, v5, v176
    v_add_f32 v6, v6, v177
    v_fmac_f32 v7, v176, v176
    v_fmac_f32 v8, v177, v177
    s_waitcnt lgkmcnt(7)
    v_mfma_f32_32x32x16_bf16 v[64:79], v[128:131], v[172:175], v[64:79]
    ds_read_b128 v[156:159], v2 offset:48128
    v_add_f32 v5, v5, v178
    v_add_f32 v6, v6, v179
    v_fmac_f32 v7, v178, v178
    s_waitcnt lgkmcnt(7)
    v_mfma_f32_32x32x16_bf16 v[80:95], v[132:135], v[172:175], v[80:95]
    ds_read_b128 v[128:131], v2 offset:49152
    v_fmac_f32 v8, v179, v179
    v_add_f32 v5, v5, v180
    v_add_f32 v6, v6, v181
    s_waitcnt lgkmcnt(7)
    v_mfma_f32_32x32x16_bf16 v[96:111], v[136:139], v[172:175], v[96:111]
    ds_read_b128 v[132:135], v2 offset:50176
    v_fmac_f32 v7, v180, v180
    v_fmac_f32 v8, v181, v181
    v_add_f32 v5, v5, v182
    s_waitcnt lgkmcnt(7)
    v_mfma_f32_32x32x16_bf16 v[112:127], v[140:143], v[172:175], v[112:127]
    ds_read_b128 v[136:139], v2 offset:51200
    v_add_f32 v6, v6, v183
    v_fmac_f32 v7, v182, v182
    v_fmac_f32 v8, v183, v183
    s_waitcnt lgkmcnt(6)
    v_mfma_f32_32x32x16_bf16 v[16:31], v[144:147], v[160:163], v[16:31]
    ds_read_b128 v[164:167], v11 offset:6144
    ds_read_b128 v[140:143], v2 offset:52224
    v_lshlrev_b32 v176, 16, v160
    v_and_b32 v177, s30, v160
    v_lshlrev_b32 v178, 16, v161
    v_and_b32 v179, s30, v161
    s_waitcnt lgkmcnt(7)
    v_mfma_f32_32x32x16_bf16 v[32:47], v[148:151], v[160:163], v[32:47]
    ds_read_b128 v[144:147], v2 offset:53248
    v_lshlrev_b32 v180, 16, v162
    v_and_b32 v181, s30, v162
    v_lshlrev_b32 v182, 16, v163
    v_and_b32 v183, s30, v163
    s_waitcnt lgkmcnt(7)
    v_mfma_f32_32x32x16_bf16 v[48:63], v[152:155], v[160:163], v[48:63]
    ds_read_b128 v[148:151], v2 offset:54272
    v_add_f32 v5, v5, v176
    v_add_f32 v6, v6, v177
    v_fmac_f32 v7, v176, v176
    v_fmac_f32 v8, v177, v177
    s_waitcnt lgkmcnt(7)
    v_mfma_f32_32x32x16_bf16 v[64:79], v[156:159], v[160:163], v[64:79]
    ds_read_b128 v[152:155], v2 offset:55296
    v_add_f32 v5, v5, v178
    v_add_f32 v6, v6, v179
    v_fmac_f32 v7, v178, v178
    s_waitcnt lgkmcnt(7)
    v_mfma_f32_32x32x16_bf16 v[80:95], v[128:131], v[160:163], v[80:95]
    ds_read_b128 v[156:159], v2 offset:56320
    v_fmac_f32 v8, v179, v179
    v_add_f32 v5, v5, v180
    v_add_f32 v6, v6, v181
    s_waitcnt lgkmcnt(7)
    v_mfma_f32_32x32x16_bf16 v[96:111], v[132:135], v[160:163], v[96:111]
    ds_read_b128 v[128:131], v3 offset:0
    v_fmac_f32 v7, v180, v180
    v_fmac_f32 v8, v181, v181
    v_add_f32 v5, v5, v182
    s_waitcnt lgkmcnt(7)
    v_mfma_f32_32x32x16_bf16 v[112:127], v[136:139], v[160:163], v[112:127]
    ds_read_b128 v[132:135], v3 offset:1024
    v_add_f32 v6, v6, v183
    v_fmac_f32 v7, v182, v182
    v_fmac_f32 v8, v183, v183
    s_waitcnt lgkmcnt(6)
    v_mfma_f32_32x32x16_bf16 v[16:31], v[140:143], v[164:167], v[16:31]
    s_barrier
    ds_read_b128 v[168:171], v11 offset:24576
    ds_read_b128 v[136:139], v3 offset:10240
    v_lshlrev_b32 v176, 16, v164
    v_and_b32 v177, s30, v164
    v_lshlrev_b32 v178, 16, v165
    v_and_b32 v179, s30, v165
    s_waitcnt lgkmcnt(7)
    v_mfma_f32_32x32x16_bf16 v[32:47], v[144:147], v[164:167], v[32:47]
    ds_read_b128 v[140:143], v3 offset:11264
    v_lshlrev_b32 v180, 16, v166
    v_and_b32 v181, s30, v166
    v_lshlrev_b32 v182, 16, v167
    v_and_b32 v183, s30, v167
    s_waitcnt lgkmcnt(7)
    v_mfma_f32_32x32x16_bf16 v[48:63], v[148:151], v[164:167], v[48:63]
    ds_read_b128 v[144:147], v3 offset:12288
    v_add_f32 v5, v5, v176
    v_add_f32 v6, v6, v177
    v_fmac_f32 v7, v176, v176
    v_fmac_f32 v8, v177, v177
    s_waitcnt lgkmcnt(7)
    v_mfma_f32_32x32x16_bf16 v[64:79], v[152:155], v[164:167], v[64:79]
    ds_read_b128 v[148:151], v3 offset:13312
    v_add_f32 v5, v5, v178
    v_add_f32 v6, v6, v179
    v_fmac_f32 v7, v178, v178
    s_waitcnt lgkmcnt(7)
    v_mfma_f32_32x32x16_bf16 v[80:95], v[156:159], v[164:167], v[80:95]
    ds_read_b128 v[152:155], v3 offset:14336
    v_fmac_f32 v8, v179, v179
    v_add_f32 v5, v5, v180
    v_add_f32 v6, v6, v181
    s_waitcnt lgkmcnt(7)
    v_mfma_f32_32x32x16_bf16 v[96:111], v[128:131], v[164:167], v[96:111]
    ds_read_b128 v[156:159], v3 offset:15360
    v_fmac_f32 v7, v180, v180
    v_fmac_f32 v8, v181, v181
    v_add_f32 v5, v5, v182
    s_waitcnt lgkmcnt(7)
    v_mfma_f32_32x32x16_bf16 v[112:127], v[132:135], v[164:167], v[112:127]
    ds_read_b128 v[128:131], v3 offset:16384
    v_add_f32 v6, v6, v183
    v_fmac_f32 v7, v182, v182
    v_fmac_f32 v8, v183, v183
    s_waitcnt lgkmcnt(6)
    v_mfma_f32_32x32x16_bf16 v[16:31], v[136:139], v[168:171], v[16:31]
    ds_read_b128 v[172:175], v11 offset:28672
    ds_read_b128 v[132:135], v3 offset:17408
    v_lshlrev_b32 v176, 16, v168
    v_and_b32 v177, s30, v168
    v_lshlrev_b32 v178, 16, v169
    v_and_b32 v179, s30, v169
    s_waitcnt lgkmcnt(7)
    v_mfma_f32_32x32x16_bf16 v[32:47], v[140:143], v[168:171], v[32:47]
    ds_read_b128 v[136:139], v3 offset:18432
    v_lshlrev_b32 v180, 16, v170
    v_and_b32 v181, s30, v170
    v_lshlrev_b32 v182, 16, v171
    v_and_b32 v183, s30, v171
    s_waitcnt lgkmcnt(7)
    v_mfma_f32_32x32x16_bf16 v[48:63], v[144:147], v[168:171], v[48:63]
    ds_read_b128 v[140:143], v3 offset:19456
    v_add_f32 v5, v5, v176
    v_add_f32 v6, v6, v177
    v_fmac_f32 v7, v176, v176
    v_fmac_f32 v8, v177, v177
    s_waitcnt lgkmcnt(7)
    v_mfma_f32_32x32x16_bf16 v[64:79], v[148:151], v[168:171], v[64:79]
    ds_read_b128 v[144:147], v3 offset:20480
    v_add_f32 v5, v5, v178
    v_add_f32 v6, v6, v179
    v_fmac_f32 v7, v178, v178
    s_waitcnt lgkmcnt(7)
    v_mfma_f32_32x32x16_bf16 v[80:95], v[152:155], v[168:171], v[80:95]
    ds_read_b128 v[148:151], v3 offset:21504
    v_fmac_f32 v8, v179, v179
    v_add_f32 v5, v5, v180
    v_add_f32 v6, v6, v181
    s_waitcnt lgkmcnt(7)
    v_mfma_f32_32x32x16_bf16 v[96:111], v[156:159], v[168:171], v[96:111]
    ds_read_b128 v[152:155], v3 offset:22528
    v_fmac_f32 v7, v180, v180
    v_fmac_f32 v8, v181, v181
    v_add_f32 v5, v5, v182
    s_waitcnt lgkmcnt(7)
    v_mfma_f32_32x32x16_bf16 v[112:127], v[128:131], v[168:171], v[112:127]
    ds_read_b128 v[156:159], v3 offset:23552
    v_add_f32 v6, v6, v183
    v_fmac_f32 v7, v182, v182
    v_fmac_f32 v8, v183, v183
    s_waitcnt lgkmcnt(6)
    v_mfma_f32_32x32x16_bf16 v[16:31], v[132:135], v[172:175], v[16:31]
    v_lshlrev_b32 v176, 16, v172
    v_and_b32 v177, s30, v172
    v_lshlrev_b32 v178, 16, v173
    v_and_b32 v179, s30, v173
    s_waitcnt lgkmcnt(5)
    v_mfma_f32_32x32x16_bf16 v[32:47], v[136:139], v[172:175], v[32:47]
    v_lshlrev_b32 v180, 16, v174
    v_and_b32 v181, s30, v174
    v_lshlrev_b32 v182, 16, v175
    v_and_b32 v183, s30, v175
    s_waitcnt lgkmcnt(4)
    v_mfma_f32_32x32x16_bf16 v[48:63], v[140:143], v[172:175], v[48:63]
    v_add_f32 v5, v5, v176
    v_add_f32 v6, v6, v177
    v_fmac_f32 v7, v176, v176
    v_fmac_f32 v8, v177, v177
    s_waitcnt lgkmcnt(3)
    v_mfma_f32_32x32x16_bf16 v[64:79], v[144:147], v[172:175], v[64:79]
    v_add_f32 v5, v5, v178
    v_add_f32 v6, v6, v179
    v_fmac_f32 v7, v178, v178
    s_waitcnt lgkmcnt(2)
    v_mfma_f32_32x32x16_bf16 v[80:95], v[148:151], v[172:175], v[80:95]
    v_fmac_f32 v8, v179, v179
    v_add_f32 v5, v5, v180
    v_add_f32 v6, v6, v181
    s_waitcnt lgkmcnt(1)
    v_mfma_f32_32x32x16_bf16 v[96:111], v[152:155], v[172:175], v[96:111]
    v_fmac_f32 v7, v180, v180
    v_fmac_f32 v8, v181, v181
    v_add_f32 v5, v5, v182
    s_waitcnt lgkmcnt(0)
    v_mfma_f32_32x32x16_bf16 v[112:127], v[156:159], v[172:175], v[112:127]
    v_add_f32 v6, v6, v183
    v_fmac_f32 v7, v182, v182
    v_fmac_f32 v8, v183, v183
    s_barrier
    v_add_f32 v5, v5, v6
    v_add_f32 v7, v7, v8
    v_mov_b32 v6, v5
    v_mov_b32 v8, v7
    s_nop 0
    v_permlane32_swap_b32 v6, v5
    v_permlane32_swap_b32 v8, v7
    s_nop 0
    v_add_f32 v5, v5, v6
    v_add_f32 v7, v7, v8
    v_mul_f32 v5, 0xbb000000, v5
    v_mul_f32 v7, 0x3b000000, v7
    v_fma_f32 v7, -v5, v5, v7
    v_max_f32 v7, 0, v7
    v_add_f32 v7, 0x3727c5ac, v7
    v_rsq_f32 v8, v7
    v_sqrt_f32 v14, v7
    v_mov_b32 v10, v5
    v_lshrrev_b32 v9, 5, v0
    v_and_b32 v9, 1, v9
    v_lshlrev_b32 v9, 6, v9
    v_add_u32 v9, 162816, v9
    v_mul_f32 v12, 0xbfb8aa3b, v8
    s_mul_i32 s22, s17, 112
    s_mul_i32 s23, s18, 7
    s_add_u32 s22, s22, s23
    s_lshl_b32 s22, s22, 10
    s_add_u32 s22, s22, 10485760
    s_add_u32 s4, s12, s22
    s_addc_u32 s5, s13, 0
    v_add_u32 v2, 4096, v1
    ds_read_b128 v[128:131], v9 offset:0
    ds_read_b128 v[132:135], v9 offset:16
    ds_read_b128 v[136:139], v9 offset:32
    ds_read_b128 v[140:143], v9 offset:48
    ds_read_b128 v[144:147], v9 offset:128
    ds_read_b128 v[148:151], v9 offset:144
    ds_read_b128 v[152:155], v9 offset:160
    ds_read_b128 v[156:159], v9 offset:176
    ds_read_b128 v[160:163], v9 offset:256
    ds_read_b128 v[164:167], v9 offset:272
    ds_read_b128 v[168:171], v9 offset:288
    ds_read_b128 v[172:175], v9 offset:304
    s_waitcnt lgkmcnt(8)
    v_pk_fma_f32 v[16:17], v[128:129], v[10:11], v[16:17] op_sel_hi:[1,0,1]
    v_pk_fma_f32 v[18:19], v[130:131], v[10:11], v[18:19] op_sel_hi:[1,0,1]
    v_pk_fma_f32 v[20:21], v[132:133], v[10:11], v[20:21] op_sel_hi:[1,0,1]
    v_pk_fma_f32 v[22:23], v[134:135], v[10:11], v[22:23] op_sel_hi:[1,0,1]
    v_pk_fma_f32 v[24:25], v[136:137], v[10:11], v[24:25] op_sel_hi:[1,0,1]
    v_pk_fma_f32 v[26:27], v[138:139], v[10:11], v[26:27] op_sel_hi:[1,0,1]
    v_pk_fma_f32 v[28:29], v[140:141], v[10:11], v[28:29] op_sel_hi:[1,0,1]
    v_pk_fma_f32 v[30:31], v[142:143], v[10:11], v[30:31] op_sel_hi:[1,0,1]
    ds_read_b128 v[128:131], v9 offset:384
    ds_read_b128 v[132:135], v9 offset:400
    ds_read_b128 v[136:139], v9 offset:416
    ds_read_b128 v[140:143], v9 offset:432
    v_pk_mul_f32 v[16:17], v[16:17], v[12:13] op_sel_hi:[1,0]
    v_pk_mul_f32 v[18:19], v[18:19], v[12:13] op_sel_hi:[1,0]
    v_pk_mul_f32 v[20:21], v[20:21], v[12:13] op_sel_hi:[1,0]
    v_pk_mul_f32 v[22:23], v[22:23], v[12:13] op_sel_hi:[1,0]
    v_exp_f32 v16, v16
    v_exp_f32 v17, v17
    v_exp_f32 v18, v18
    v_exp_f32 v19, v19
    v_exp_f32 v20, v20
    v_exp_f32 v21, v21
    v_exp_f32 v22, v22
    v_exp_f32 v23, v23
    s_nop 0
    v_pk_fma_f32 v[16:17], v[16:17], v[14:15], v[14:15] op_sel_hi:[1,0,0]
    v_pk_fma_f32 v[18:19], v[18:19], v[14:15], v[14:15] op_sel_hi:[1,0,0]
    v_pk_fma_f32 v[20:21], v[20:21], v[14:15], v[14:15] op_sel_hi:[1,0,0]
    v_pk_fma_f32 v[22:23], v[22:23], v[14:15], v[14:15] op_sel_hi:[1,0,0]
    v_rcp_f32 v16, v16
    v_rcp_f32 v17, v17
    v_rcp_f32 v18, v18
    v_rcp_f32 v19, v19
    v_rcp_f32 v20, v20
    v_rcp_f32 v21, v21
    v_rcp_f32 v22, v22
    v_rcp_f32 v23, v23
    s_nop 0
    v_pk_mul_f32 v[16:17], v[16:17], v[24:25]
    v_pk_mul_f32 v[18:19], v[18:19], v[26:27]
    v_pk_mul_f32 v[20:21], v[20:21], v[28:29]
    v_pk_mul_f32 v[22:23], v[22:23], v[30:31]
    v_cvt_pk_bf16_f32 v176, v16, v17
    v_cvt_pk_bf16_f32 v177, v18, v19
    v_cvt_pk_bf16_f32 v178, v20, v21
    v_cvt_pk_bf16_f32 v179, v22, v23
    global_store_dwordx4 v1, v[176:179], s[4:5] offset:0 sc1
    s_waitcnt lgkmcnt(8)
    v_pk_fma_f32 v[32:33], v[144:145], v[10:11], v[32:33] op_sel_hi:[1,0,1]
    v_pk_fma_f32 v[34:35], v[146:147], v[10:11], v[34:35] op_sel_hi:[1,0,1]
    v_pk_fma_f32 v[36:37], v[148:149], v[10:11], v[36:37] op_sel_hi:[1,0,1]
    v_pk_fma_f32 v[38:39], v[150:151], v[10:11], v[38:39] op_sel_hi:[1,0,1]
    v_pk_fma_f32 v[40:41], v[152:153], v[10:11], v[40:41] op_sel_hi:[1,0,1]
    v_pk_fma_f32 v[42:43], v[154:155], v[10:11], v[42:43] op_sel_hi:[1,0,1]
    v_pk_fma_f32 v[44:45], v[156:157], v[10:11], v[44:45] op_sel_hi:[1,0,1]
    v_pk_fma_f32 v[46:47], v[158:159], v[10:11], v[46:47] op_sel_hi:[1,0,1]
    ds_read_b128 v[144:147], v9 offset:512
    ds_read_b128 v[148:151], v9 offset:528
    ds_read_b128 v[152:155], v9 offset:544
    ds_read_b128 v[156:159], v9 offset:560
    v_pk_mul_f32 v[32:33], v[32:33], v[12:13] op_sel_hi:[1,0]
    v_pk_mul_f32 v[34:35], v[34:35], v[12:13] op_sel_hi:[1,0]
    v_pk_mul_f32 v[36:37], v[36:37], v[12:13] op_sel_hi:[1,0]
    v_pk_mul_f32 v[38:39], v[38:39], v[12:13] op_sel_hi:[1,0]
    v_exp_f32 v32, v32
    v_exp_f32 v33, v33
    v_exp_f32 v34, v34
    v_exp_f32 v35, v35
    v_exp_f32 v36, v36
    v_exp_f32 v37, v37
    v_exp_f32 v38, v38
    v_exp_f32 v39, v39
    s_nop 0
    v_pk_fma_f32 v[32:33], v[32:33], v[14:15], v[14:15] op_sel_hi:[1,0,0]
    v_pk_fma_f32 v[34:35], v[34:35], v[14:15], v[14:15] op_sel_hi:[1,0,0]
    v_pk_fma_f32 v[36:37], v[36:37], v[14:15], v[14:15] op_sel_hi:[1,0,0]
    v_pk_fma_f32 v[38:39], v[38:39], v[14:15], v[14:15] op_sel_hi:[1,0,0]
    v_rcp_f32 v32, v32
    v_rcp_f32 v33, v33
    v_rcp_f32 v34, v34
    v_rcp_f32 v35, v35
    v_rcp_f32 v36, v36
    v_rcp_f32 v37, v37
    v_rcp_f32 v38, v38
    v_rcp_f32 v39, v39
    s_nop 0
    v_pk_mul_f32 v[32:33], v[32:33], v[40:41]
    v_pk_mul_f32 v[34:35], v[34:35], v[42:43]
    v_pk_mul_f32 v[36:37], v[36:37], v[44:45]
    v_pk_mul_f32 v[38:39], v[38:39], v[46:47]
    v_cvt_pk_bf16_f32 v180, v32, v33
    v_cvt_pk_bf16_f32 v181, v34, v35
    v_cvt_pk_bf16_f32 v182, v36, v37
    v_cvt_pk_bf16_f32 v183, v38, v39
    global_store_dwordx4 v1, v[180:183], s[4:5] offset:1024 sc1
    s_waitcnt lgkmcnt(8)
    v_pk_fma_f32 v[48:49], v[160:161], v[10:11], v[48:49] op_sel_hi:[1,0,1]
    v_pk_fma_f32 v[50:51], v[162:163], v[10:11], v[50:51] op_sel_hi:[1,0,1]
    v_pk_fma_f32 v[52:53], v[164:165], v[10:11], v[52:53] op_sel_hi:[1,0,1]
    v_pk_fma_f32 v[54:55], v[166:167], v[10:11], v[54:55] op_sel_hi:[1,0,1]
    v_pk_fma_f32 v[56:57], v[168:169], v[10:11], v[56:57] op_sel_hi:[1,0,1]
    v_pk_fma_f32 v[58:59], v[170:171], v[10:11], v[58:59] op_sel_hi:[1,0,1]
    v_pk_fma_f32 v[60:61], v[172:173], v[10:11], v[60:61] op_sel_hi:[1,0,1]
    v_pk_fma_f32 v[62:63], v[174:175], v[10:11], v[62:63] op_sel_hi:[1,0,1]
    ds_read_b128 v[160:163], v9 offset:640
    ds_read_b128 v[164:167], v9 offset:656
    ds_read_b128 v[168:171], v9 offset:672
    ds_read_b128 v[172:175], v9 offset:688
    v_pk_mul_f32 v[48:49], v[48:49], v[12:13] op_sel_hi:[1,0]
    v_pk_mul_f32 v[50:51], v[50:51], v[12:13] op_sel_hi:[1,0]
    v_pk_mul_f32 v[52:53], v[52:53], v[12:13] op_sel_hi:[1,0]
    v_pk_mul_f32 v[54:55], v[54:55], v[12:13] op_sel_hi:[1,0]
    v_exp_f32 v48, v48
    v_exp_f32 v49, v49
    v_exp_f32 v50, v50
    v_exp_f32 v51, v51
    v_exp_f32 v52, v52
    v_exp_f32 v53, v53
    v_exp_f32 v54, v54
    v_exp_f32 v55, v55
    s_nop 0
    v_pk_fma_f32 v[48:49], v[48:49], v[14:15], v[14:15] op_sel_hi:[1,0,0]
    v_pk_fma_f32 v[50:51], v[50:51], v[14:15], v[14:15] op_sel_hi:[1,0,0]
    v_pk_fma_f32 v[52:53], v[52:53], v[14:15], v[14:15] op_sel_hi:[1,0,0]
    v_pk_fma_f32 v[54:55], v[54:55], v[14:15], v[14:15] op_sel_hi:[1,0,0]
    v_rcp_f32 v48, v48
    v_rcp_f32 v49, v49
    v_rcp_f32 v50, v50
    v_rcp_f32 v51, v51
    v_rcp_f32 v52, v52
    v_rcp_f32 v53, v53
    v_rcp_f32 v54, v54
    v_rcp_f32 v55, v55
    s_nop 0
    v_pk_mul_f32 v[48:49], v[48:49], v[56:57]
    v_pk_mul_f32 v[50:51], v[50:51], v[58:59]
    v_pk_mul_f32 v[52:53], v[52:53], v[60:61]
    v_pk_mul_f32 v[54:55], v[54:55], v[62:63]
    v_cvt_pk_bf16_f32 v176, v48, v49
    v_cvt_pk_bf16_f32 v177, v50, v51
    v_cvt_pk_bf16_f32 v178, v52, v53
    v_cvt_pk_bf16_f32 v179, v54, v55
    global_store_dwordx4 v1, v[176:179], s[4:5] offset:2048 sc1
    s_waitcnt lgkmcnt(8)
    v_pk_fma_f32 v[64:65], v[128:129], v[10:11], v[64:65] op_sel_hi:[1,0,1]
    v_pk_fma_f32 v[66:67], v[130:131], v[10:11], v[66:67] op_sel_hi:[1,0,1]
    v_pk_fma_f32 v[68:69], v[132:133], v[10:11], v[68:69] op_sel_hi:[1,0,1]
    v_pk_fma_f32 v[70:71], v[134:135], v[10:11], v[70:71] op_sel_hi:[1,0,1]
    v_pk_fma_f32 v[72:73], v[136:137], v[10:11], v[72:73] op_sel_hi:[1,0,1]
    v_pk_fma_f32 v[74:75], v[138:139], v[10:11], v[74:75] op_sel_hi:[1,0,1]
    v_pk_fma_f32 v[76:77], v[140:141], v[10:11], v[76:77] op_sel_hi:[1,0,1]
    v_pk_fma_f32 v[78:79], v[142:143], v[10:11], v[78:79] op_sel_hi:[1,0,1]
    ds_read_b128 v[128:131], v9 offset:768
    ds_read_b128 v[132:135], v9 offset:784
    ds_read_b128 v[136:139], v9 offset:800
    ds_read_b128 v[140:143], v9 offset:816
    v_pk_mul_f32 v[64:65], v[64:65], v[12:13] op_sel_hi:[1,0]
    v_pk_mul_f32 v[66:67], v[66:67], v[12:13] op_sel_hi:[1,0]
    v_pk_mul_f32 v[68:69], v[68:69], v[12:13] op_sel_hi:[1,0]
    v_pk_mul_f32 v[70:71], v[70:71], v[12:13] op_sel_hi:[1,0]
    v_exp_f32 v64, v64
    v_exp_f32 v65, v65
    v_exp_f32 v66, v66
    v_exp_f32 v67, v67
    v_exp_f32 v68, v68
    v_exp_f32 v69, v69
    v_exp_f32 v70, v70
    v_exp_f32 v71, v71
    s_nop 0
    v_pk_fma_f32 v[64:65], v[64:65], v[14:15], v[14:15] op_sel_hi:[1,0,0]
    v_pk_fma_f32 v[66:67], v[66:67], v[14:15], v[14:15] op_sel_hi:[1,0,0]
    v_pk_fma_f32 v[68:69], v[68:69], v[14:15], v[14:15] op_sel_hi:[1,0,0]
    v_pk_fma_f32 v[70:71], v[70:71], v[14:15], v[14:15] op_sel_hi:[1,0,0]
    v_rcp_f32 v64, v64
    v_rcp_f32 v65, v65
    v_rcp_f32 v66, v66
    v_rcp_f32 v67, v67
    v_rcp_f32 v68, v68
    v_rcp_f32 v69, v69
    v_rcp_f32 v70, v70
    v_rcp_f32 v71, v71
    s_nop 0
    v_pk_mul_f32 v[64:65], v[64:65], v[72:73]
    v_pk_mul_f32 v[66:67], v[66:67], v[74:75]
    v_pk_mul_f32 v[68:69], v[68:69], v[76:77]
    v_pk_mul_f32 v[70:71], v[70:71], v[78:79]
    v_cvt_pk_bf16_f32 v180, v64, v65
    v_cvt_pk_bf16_f32 v181, v66, v67
    v_cvt_pk_bf16_f32 v182, v68, v69
    v_cvt_pk_bf16_f32 v183, v70, v71
    global_store_dwordx4 v1, v[180:183], s[4:5] offset:3072 sc1
    s_waitcnt lgkmcnt(8)
    v_pk_fma_f32 v[80:81], v[144:145], v[10:11], v[80:81] op_sel_hi:[1,0,1]
    v_pk_fma_f32 v[82:83], v[146:147], v[10:11], v[82:83] op_sel_hi:[1,0,1]
    v_pk_fma_f32 v[84:85], v[148:149], v[10:11], v[84:85] op_sel_hi:[1,0,1]
    v_pk_fma_f32 v[86:87], v[150:151], v[10:11], v[86:87] op_sel_hi:[1,0,1]
    v_pk_fma_f32 v[88:89], v[152:153], v[10:11], v[88:89] op_sel_hi:[1,0,1]
    v_pk_fma_f32 v[90:91], v[154:155], v[10:11], v[90:91] op_sel_hi:[1,0,1]
    v_pk_fma_f32 v[92:93], v[156:157], v[10:11], v[92:93] op_sel_hi:[1,0,1]
    v_pk_fma_f32 v[94:95], v[158:159], v[10:11], v[94:95] op_sel_hi:[1,0,1]
    v_pk_mul_f32 v[80:81], v[80:81], v[12:13] op_sel_hi:[1,0]
    v_pk_mul_f32 v[82:83], v[82:83], v[12:13] op_sel_hi:[1,0]
    v_pk_mul_f32 v[84:85], v[84:85], v[12:13] op_sel_hi:[1,0]
    v_pk_mul_f32 v[86:87], v[86:87], v[12:13] op_sel_hi:[1,0]
    v_exp_f32 v80, v80
    v_exp_f32 v81, v81
    v_exp_f32 v82, v82
    v_exp_f32 v83, v83
    v_exp_f32 v84, v84
    v_exp_f32 v85, v85
    v_exp_f32 v86, v86
    v_exp_f32 v87, v87
    s_nop 0
    v_pk_fma_f32 v[80:81], v[80:81], v[14:15], v[14:15] op_sel_hi:[1,0,0]
    v_pk_fma_f32 v[82:83], v[82:83], v[14:15], v[14:15] op_sel_hi:[1,0,0]
    v_pk_fma_f32 v[84:85], v[84:85], v[14:15], v[14:15] op_sel_hi:[1,0,0]
    v_pk_fma_f32 v[86:87], v[86:87], v[14:15], v[14:15] op_sel_hi:[1,0,0]
    v_rcp_f32 v80, v80
    v_rcp_f32 v81, v81
    v_rcp_f32 v82, v82
    v_rcp_f32 v83, v83
    v_rcp_f32 v84, v84
    v_rcp_f32 v85, v85
    v_rcp_f32 v86, v86
    v_rcp_f32 v87, v87
    s_nop 0
    v_pk_mul_f32 v[80:81], v[80:81], v[88:89]
    v_pk_mul_f32 v[82:83], v[82:83], v[90:91]
    v_pk_mul_f32 v[84:85], v[84:85], v[92:93]
    v_pk_mul_f32 v[86:87], v[86:87], v[94:95]
    v_cvt_pk_bf16_f32 v176, v80, v81
    v_cvt_pk_bf16_f32 v177, v82, v83
    v_cvt_pk_bf16_f32 v178, v84, v85
    v_cvt_pk_bf16_f32 v179, v86, v87
    global_store_dwordx4 v2, v[176:179], s[4:5] offset:0 sc1
    s_waitcnt lgkmcnt(4)
    v_pk_fma_f32 v[96:97], v[160:161], v[10:11], v[96:97] op_sel_hi:[1,0,1]
    v_pk_fma_f32 v[98:99], v[162:163], v[10:11], v[98:99] op_sel_hi:[1,0,1]
    v_pk_fma_f32 v[100:101], v[164:165], v[10:11], v[100:101] op_sel_hi:[1,0,1]
    v_pk_fma_f32 v[102:103], v[166:167], v[10:11], v[102:103] op_sel_hi:[1,0,1]
    v_pk_fma_f32 v[104:105], v[168:169], v[10:11], v[104:105] op_sel_hi:[1,0,1]
    v_pk_fma_f32 v[106:107], v[170:171], v[10:11], v[106:107] op_sel_hi:[1,0,1]
    v_pk_fma_f32 v[108:109], v[172:173], v[10:11], v[108:109] op_sel_hi:[1,0,1]
    v_pk_fma_f32 v[110:111], v[174:175], v[10:11], v[110:111] op_sel_hi:[1,0,1]
    v_pk_mul_f32 v[96:97], v[96:97], v[12:13] op_sel_hi:[1,0]
    v_pk_mul_f32 v[98:99], v[98:99], v[12:13] op_sel_hi:[1,0]
    v_pk_mul_f32 v[100:101], v[100:101], v[12:13] op_sel_hi:[1,0]
    v_pk_mul_f32 v[102:103], v[102:103], v[12:13] op_sel_hi:[1,0]
    v_exp_f32 v96, v96
    v_exp_f32 v97, v97
    v_exp_f32 v98, v98
    v_exp_f32 v99, v99
    v_exp_f32 v100, v100
    v_exp_f32 v101, v101
    v_exp_f32 v102, v102
    v_exp_f32 v103, v103
    s_nop 0
    v_pk_fma_f32 v[96:97], v[96:97], v[14:15], v[14:15] op_sel_hi:[1,0,0]
    v_pk_fma_f32 v[98:99], v[98:99], v[14:15], v[14:15] op_sel_hi:[1,0,0]
    v_pk_fma_f32 v[100:101], v[100:101], v[14:15], v[14:15] op_sel_hi:[1,0,0]
    v_pk_fma_f32 v[102:103], v[102:103], v[14:15], v[14:15] op_sel_hi:[1,0,0]
    v_rcp_f32 v96, v96
    v_rcp_f32 v97, v97
    v_rcp_f32 v98, v98
    v_rcp_f32 v99, v99
    v_rcp_f32 v100, v100
    v_rcp_f32 v101, v101
    v_rcp_f32 v102, v102
    v_rcp_f32 v103, v103
    s_nop 0
    v_pk_mul_f32 v[96:97], v[96:97], v[104:105]
    v_pk_mul_f32 v[98:99], v[98:99], v[106:107]
    v_pk_mul_f32 v[100:101], v[100:101], v[108:109]
    v_pk_mul_f32 v[102:103], v[102:103], v[110:111]
    v_cvt_pk_bf16_f32 v180, v96, v97
    v_cvt_pk_bf16_f32 v181, v98, v99
    v_cvt_pk_bf16_f32 v182, v100, v101
    v_cvt_pk_bf16_f32 v183, v102, v103
    global_store_dwordx4 v2, v[180:183], s[4:5] offset:1024 sc1
    s_waitcnt lgkmcnt(0)
    v_pk_fma_f32 v[112:113], v[128:129], v[10:11], v[112:113] op_sel_hi:[1,0,1]
    v_pk_fma_f32 v[114:115], v[130:131], v[10:11], v[114:115] op_sel_hi:[1,0,1]
    v_pk_fma_f32 v[116:117], v[132:133], v[10:11], v[116:117] op_sel_hi:[1,0,1]
    v_pk_fma_f32 v[118:119], v[134:135], v[10:11], v[118:119] op_sel_hi:[1,0,1]
    v_pk_fma_f32 v[120:121], v[136:137], v[10:11], v[120:121] op_sel_hi:[1,0,1]
    v_pk_fma_f32 v[122:123], v[138:139], v[10:11], v[122:123] op_sel_hi:[1,0,1]
    v_pk_fma_f32 v[124:125], v[140:141], v[10:11], v[124:125] op_sel_hi:[1,0,1]
    v_pk_fma_f32 v[126:127], v[142:143], v[10:11], v[126:127] op_sel_hi:[1,0,1]
    v_pk_mul_f32 v[112:113], v[112:113], v[12:13] op_sel_hi:[1,0]
    v_pk_mul_f32 v[114:115], v[114:115], v[12:13] op_sel_hi:[1,0]
    v_pk_mul_f32 v[116:117], v[116:117], v[12:13] op_sel_hi:[1,0]
    v_pk_mul_f32 v[118:119], v[118:119], v[12:13] op_sel_hi:[1,0]
    v_exp_f32 v112, v112
    v_exp_f32 v113, v113
    v_exp_f32 v114, v114
    v_exp_f32 v115, v115
    v_exp_f32 v116, v116
    v_exp_f32 v117, v117
    v_exp_f32 v118, v118
    v_exp_f32 v119, v119
    s_nop 0
    v_pk_fma_f32 v[112:113], v[112:113], v[14:15], v[14:15] op_sel_hi:[1,0,0]
    v_pk_fma_f32 v[114:115], v[114:115], v[14:15], v[14:15] op_sel_hi:[1,0,0]
    v_pk_fma_f32 v[116:117], v[116:117], v[14:15], v[14:15] op_sel_hi:[1,0,0]
    v_pk_fma_f32 v[118:119], v[118:119], v[14:15], v[14:15] op_sel_hi:[1,0,0]
    v_rcp_f32 v112, v112
    v_rcp_f32 v113, v113
    v_rcp_f32 v114, v114
    v_rcp_f32 v115, v115
    v_rcp_f32 v116, v116
    v_rcp_f32 v117, v117
    v_rcp_f32 v118, v118
    v_rcp_f32 v119, v119
    s_nop 0
    v_pk_mul_f32 v[112:113], v[112:113], v[120:121]
    v_pk_mul_f32 v[114:115], v[114:115], v[122:123]
    v_pk_mul_f32 v[116:117], v[116:117], v[124:125]
    v_pk_mul_f32 v[118:119], v[118:119], v[126:127]
    v_cvt_pk_bf16_f32 v176, v112, v113
    v_cvt_pk_bf16_f32 v177, v114, v115
    v_cvt_pk_bf16_f32 v178, v116, v117
    v_cvt_pk_bf16_f32 v179, v118, v119
    global_store_dwordx4 v2, v[176:179], s[4:5] offset:2048 sc1
    s_lshl_b32 s43, s40, 8
    s_add_u32 s43, s43, 18874368
    s_lshl_b32 s43, s40, 4
    s_add_u32 s43, s43, s18
    s_lshl_b32 s43, s43, 8
    s_add_u32 s43, s43, 18907136
    s_waitcnt vmcnt(0)
    v_mov_b32 v16, 163712
    v_mov_b32 v17, 1
    s_mov_b64 s[36:37], exec
    s_mov_b64 exec, 1
    ds_add_rtn_u32 v18, v16, v17
    s_waitcnt lgkmcnt(0)
    v_readfirstlane_b32 s38, v18
    s_nop 3
    s_cmp_lg_u32 s38, 3
    s_cbranch_scc1 .sig_k3_kernel_4
    v_mov_b32 v16, s43
    global_atomic_add v16, v17, s[12:13] sc1
.sig_k3_kernel_4:
    s_mov_b64 exec, s[36:37]
    s_and_b32 s44, s24, 1
    s_lshr_b32 s45, s24, 1
    s_lshl_b32 s28, s42, 1
    s_add_u32 s28, s28, s45
    v_mov_b32 v16, 0
    v_mov_b32 v17, 0
    v_mov_b32 v18, 0
    v_mov_b32 v19, 0
    v_mov_b32 v20, 0
    v_mov_b32 v21, 0
    v_mov_b32 v22, 0
    v_mov_b32 v23, 0
    v_mov_b32 v24, 0
    v_mov_b32 v25, 0
    v_mov_b32 v26, 0
    v_mov_b32 v27, 0
    v_mov_b32 v28, 0
    v_mov_b32 v29, 0
    v_mov_b32 v30, 0
    v_mov_b32 v31, 0
    s_lshl_b32 s20, s44, 10
    v_add_u32 v2, s20, v1
    v_add_u32 v3, 40960, v2
    v_add_u32 v12, 81920, v2
    s_lshl_b32 s20, s45, 12
    s_add_u32 s20, s20, 81920
    v_add_u32 v4, s20, v1
    v_and_b32 v9, 63, v0
    v_and_b32 v5, 31, v9
    v_lshrrev_b32 v6, 5, v9
    s_lshl_b32 s20, s41, 4
    s_lshl_b32 s21, s44, 3
    s_add_u32 s20, s20, s21
    v_lshl_add_u32 v7, v6, 2, s20
    s_lshl_b32 s21, s28, 15
    s_add_u32 s21, s21, 2097152
    v_lshl_add_u32 v8, v5, 4, s21
    s_cmp_ge_u32 s41, 4
    s_cbranch_scc1 .L_k4_up
    v_add_u32 v10, 63, v7
    v_and_b32 v10, 63, v10
    v_lshl_add_u32 v10, v10, 9, v8
    v_lshl_add_u32 v11, v7, 9, v8
    global_load_dword v97, v10, s[12:13] offset:4 sc1
    global_load_dwordx2 v[98:99], v11, s[12:13] offset:0 sc1
    global_load_dwordx2 v[100:101], v11, s[12:13] offset:512 sc1
    global_load_dwordx2 v[102:103], v11, s[12:13] offset:1024 sc1
    global_load_dwordx2 v[104:105], v11, s[12:13] offset:1536 sc1
    s_branch .L_k4_j
.L_k4_up:
    v_sub_u32 v10, 124, v7
    v_lshl_add_u32 v11, v10, 9, v8
    global_load_dwordx2 v[98:99], v11, s[12:13] offset:1544 sc1
    global_load_dwordx2 v[100:101], v11, s[12:13] offset:1032 sc1
    global_load_dwordx2 v[102:103], v11, s[12:13] offset:520 sc1
    global_load_dwordx2 v[104:105], v11, s[12:13] offset:8 sc1
.L_k4_j:
    v_lshlrev_b32 v6, 16, v5
    s_lshl_b32 s20, s28, 10
    v_add_u32 v6, s20, v6
    v_lshl_add_u32 v6, v7, 3, v6
    s_barrier
    ds_read_b128 v[32:35], v2 offset:0
    ds_read_b128 v[36:39], v4 offset:0
    ds_read_b128 v[40:43], v2 offset:2048
    ds_read_b128 v[44:47], v4 offset:1024
    ds_read_b128 v[48:51], v2 offset:4096
    ds_read_b128 v[52:55], v4 offset:2048
    s_waitcnt lgkmcnt(4)
    v_mfma_f32_32x32x16_bf16 v[16:31], v[32:35], v[36:39], v[16:31]
    ds_read_b128 v[56:59], v2 offset:6144
    ds_read_b128 v[60:63], v4 offset:3072
    s_waitcnt lgkmcnt(4)
    v_mfma_f32_32x32x16_bf16 v[16:31], v[40:43], v[44:47], v[16:31]
    s_barrier
    ds_read_b128 v[32:35], v2 offset:8192
    ds_read_b128 v[36:39], v4 offset:8192
    s_waitcnt lgkmcnt(4)
    v_mfma_f32_32x32x16_bf16 v[16:31], v[48:51], v[52:55], v[16:31]
    ds_read_b128 v[40:43], v2 offset:10240
    ds_read_b128 v[44:47], v4 offset:9216
    s_waitcnt lgkmcnt(4)
    v_mfma_f32_32x32x16_bf16 v[16:31], v[56:59], v[60:63], v[16:31]
    ds_read_b128 v[48:51], v2 offset:12288
    ds_read_b128 v[52:55], v4 offset:10240
    s_waitcnt lgkmcnt(4)
    v_mfma_f32_32x32x16_bf16 v[16:31], v[32:35], v[36:39], v[16:31]
    ds_read_b128 v[56:59], v2 offset:14336
    ds_read_b128 v[60:63], v4 offset:11264
    s_waitcnt lgkmcnt(4)
    v_mfma_f32_32x32x16_bf16 v[16:31], v[40:43], v[44:47], v[16:31]
    s_barrier
    ds_read_b128 v[32:35], v2 offset:16384
    ds_read_b128 v[36:39], v4 offset:16384
    s_waitcnt lgkmcnt(4)
    v_mfma_f32_32x32x16_bf16 v[16:31], v[48:51], v[52:55], v[16:31]
    ds_read_b128 v[40:43], v2 offset:18432
    ds_read_b128 v[44:47], v4 offset:17408
    s_waitcnt lgkmcnt(4)
    v_mfma_f32_32x32x16_bf16 v[16:31], v[56:59], v[60:63], v[16:31]
    ds_read_b128 v[48:51], v2 offset:20480
    ds_read_b128 v[52:55], v4 offset:18432
    s_waitcnt lgkmcnt(4)
    v_mfma_f32_32x32x16_bf16 v[16:31], v[32:35], v[36:39], v[16:31]
    ds_read_b128 v[56:59], v2 offset:22528
    ds_read_b128 v[60:63], v4 offset:19456
    s_waitcnt lgkmcnt(4)
    v_mfma_f32_32x32x16_bf16 v[16:31], v[40:43], v[44:47], v[16:31]
    s_barrier
    ds_read_b128 v[32:35], v2 offset:24576
    ds_read_b128 v[36:39], v4 offset:24576
    s_waitcnt lgkmcnt(4)
    v_mfma_f32_32x32x16_bf16 v[16:31], v[48:51], v[52:55], v[16:31]
    ds_read_b128 v[40:43], v2 offset:26624
    ds_read_b128 v[44:47], v4 offset:25600
    s_waitcnt lgkmcnt(4)
    v_mfma_f32_32x32x16_bf16 v[16:31], v[56:59], v[60:63], v[16:31]
    ds_read_b128 v[48:51], v2 offset:28672
    ds_read_b128 v[52:55], v4 offset:26624
    s_waitcnt lgkmcnt(4)
    v_mfma_f32_32x32x16_bf16 v[16:31], v[32:35], v[36:39], v[16:31]
    ds_read_b128 v[56:59], v2 offset:30720
    ds_read_b128 v[60:63], v4 offset:27648
    s_waitcnt lgkmcnt(4)
    v_mfma_f32_32x32x16_bf16 v[16:31], v[40:43], v[44:47], v[16:31]
    s_barrier
    ds_read_b128 v[32:35], v2 offset:32768
    ds_read_b128 v[36:39], v4 offset:32768
    s_waitcnt lgkmcnt(4)
    v_mfma_f32_32x32x16_bf16 v[16:31], v[48:51], v[52:55], v[16:31]
    ds_read_b128 v[40:43], v2 offset:34816
    ds_read_b128 v[44:47], v4 offset:33792
    s_waitcnt lgkmcnt(4)
    v_mfma_f32_32x32x16_bf16 v[16:31], v[56:59], v[60:63], v[16:31]
    ds_read_b128 v[48:51], v2 offset:36864
    ds_read_b128 v[52:55], v4 offset:34816
    s_waitcnt lgkmcnt(4)
    v_mfma_f32_32x32x16_bf16 v[16:31], v[32:35], v[36:39], v[16:31]
    ds_read_b128 v[56:59], v2 offset:38912
    ds_read_b128 v[60:63], v4 offset:35840
    s_waitcnt lgkmcnt(4)
    v_mfma_f32_32x32x16_bf16 v[16:31], v[40:43], v[44:47], v[16:31]
    s_barrier
    ds_read_b128 v[32:35], v3 offset:0
    ds_read_b128 v[36:39], v4 offset:40960
    s_waitcnt lgkmcnt(4)
    v_mfma_f32_32x32x16_bf16 v[16:31], v[48:51], v[52:55], v[16:31]
    ds_read_b128 v[40:43], v3 offset:2048
    ds_read_b128 v[44:47], v4 offset:41984
    s_waitcnt lgkmcnt(4)
    v_mfma_f32_32x32x16_bf16 v[16:31], v[56:59], v[60:63], v[16:31]
    ds_read_b128 v[48:51], v3 offset:4096
    ds_read_b128 v[52:55], v4 offset:43008
    s_waitcnt lgkmcnt(4)
    v_mfma_f32_32x32x16_bf16 v[16:31], v[32:35], v[36:39], v[16:31]
    ds_read_b128 v[56:59], v3 offset:6144
    ds_read_b128 v[60:63], v4 offset:44032
    s_waitcnt lgkmcnt(4)
    v_mfma_f32_32x32x16_bf16 v[16:31], v[40:43], v[44:47], v[16:31]
    s_barrier
    ds_read_b128 v[32:35], v3 offset:8192
    ds_read_b128 v[36:39], v4 offset:0
    s_waitcnt lgkmcnt(4)
    v_mfma_f32_32x32x16_bf16 v[16:31], v[48:51], v[52:55], v[16:31]
    ds_read_b128 v[40:43], v3 offset:10240
    ds_read_b128 v[44:47], v4 offset:1024
    s_waitcnt lgkmcnt(4)
    v_mfma_f32_32x32x16_bf16 v[16:31], v[56:59], v[60:63], v[16:31]
    ds_read_b128 v[48:51], v3 offset:12288
    ds_read_b128 v[52:55], v4 offset:2048
    s_waitcnt lgkmcnt(4)
    v_mfma_f32_32x32x16_bf16 v[16:31], v[32:35], v[36:39], v[16:31]
    ds_read_b128 v[56:59], v3 offset:14336
    ds_read_b128 v[60:63], v4 offset:3072
    s_waitcnt lgkmcnt(4)
    v_mfma_f32_32x32x16_bf16 v[16:31], v[40:43], v[44:47], v[16:31]
    s_barrier
    ds_read_b128 v[32:35], v3 offset:16384
    ds_read_b128 v[36:39], v4 offset:8192
    s_waitcnt lgkmcnt(4)
    v_mfma_f32_32x32x16_bf16 v[16:31], v[48:51], v[52:55], v[16:31]
    ds_read_b128 v[40:43], v3 offset:18432
    ds_read_b128 v[44:47], v4 offset:9216
    s_waitcnt lgkmcnt(4)
    v_mfma_f32_32x32x16_bf16 v[16:31], v[56:59], v[60:63], v[16:31]
    ds_read_b128 v[48:51], v3 offset:20480
    ds_read_b128 v[52:55], v4 offset:10240
    s_waitcnt lgkmcnt(4)
    v_mfma_f32_32x32x16_bf16 v[16:31], v[32:35], v[36:39], v[16:31]
    ds_read_b128 v[56:59], v3 offset:22528
    ds_read_b128 v[60:63], v4 offset:11264
    s_waitcnt lgkmcnt(4)
    v_mfma_f32_32x32x16_bf16 v[16:31], v[40:43], v[44:47], v[16:31]
    s_barrier
    ds_read_b128 v[32:35], v3 offset:24576
    ds_read_b128 v[36:39], v4 offset:16384
    s_waitcnt lgkmcnt(4)
    v_mfma_f32_32x32x16_bf16 v[16:31], v[48:51], v[52:55], v[16:31]
    ds_read_b128 v[40:43], v3 offset:26624
    ds_read_b128 v[44:47], v4 offset:17408
    s_waitcnt lgkmcnt(4)
    v_mfma_f32_32x32x16_bf16 v[16:31], v[56:59], v[60:63], v[16:31]
    ds_read_b128 v[48:51], v3 offset:28672
    ds_read_b128 v[52:55], v4 offset:18432
    s_waitcnt lgkmcnt(4)
    v_mfma_f32_32x32x16_bf16 v[16:31], v[32:35], v[36:39], v[16:31]
    ds_read_b128 v[56:59], v3 offset:30720
    ds_read_b128 v[60:63], v4 offset:19456
    s_waitcnt lgkmcnt(4)
    v_mfma_f32_32x32x16_bf16 v[16:31], v[40:43], v[44:47], v[16:31]
    s_barrier
    ds_read_b128 v[32:35], v3 offset:32768
    ds_read_b128 v[36:39], v4 offset:24576
    s_waitcnt lgkmcnt(4)
    v_mfma_f32_32x32x16_bf16 v[16:31], v[48:51], v[52:55], v[16:31]
    ds_read_b128 v[40:43], v3 offset:34816
    ds_read_b128 v[44:47], v4 offset:25600
    s_waitcnt lgkmcnt(4)
    v_mfma_f32_32x32x16_bf16 v[16:31], v[56:59], v[60:63], v[16:31]
    ds_read_b128 v[48:51], v3 offset:36864
    ds_read_b128 v[52:55], v4 offset:26624
    s_waitcnt lgkmcnt(4)
    v_mfma_f32_32x32x16_bf16 v[16:31], v[32:35], v[36:39], v[16:31]
    ds_read_b128 v[56:59], v3 offset:38912
    ds_read_b128 v[60:63], v4 offset:27648
    s_waitcnt lgkmcnt(4)
    v_mfma_f32_32x32x16_bf16 v[16:31], v[40:43], v[44:47], v[16:31]
    s_barrier
    ds_read_b128 v[32:35], v2 offset:0
    ds_read_b128 v[36:39], v4 offset:32768
    s_waitcnt lgkmcnt(4)
    v_mfma_f32_32x32x16_bf16 v[16:31], v[48:51], v[52:55], v[16:31]
    ds_read_b128 v[40:43], v2 offset:2048
    ds_read_b128 v[44:47], v4 offset:33792
    s_waitcnt lgkmcnt(4)
    v_mfma_f32_32x32x16_bf16 v[16:31], v[56:59], v[60:63], v[16:31]
    ds_read_b128 v[48:51], v2 offset:4096
    ds_read_b128 v[52:55], v4 offset:34816
    s_waitcnt lgkmcnt(4)
    v_mfma_f32_32x32x16_bf16 v[16:31], v[32:35], v[36:39], v[16:31]
    ds_read_b128 v[56:59], v2 offset:6144
    ds_read_b128 v[60:63], v4 offset:35840
    s_waitcnt lgkmcnt(4)
    v_mfma_f32_32x32x16_bf16 v[16:31], v[40:43], v[44:47], v[16:31]
    s_barrier
    ds_read_b128 v[32:35], v2 offset:8192
    ds_read_b128 v[36:39], v4 offset:40960
    s_waitcnt lgkmcnt(4)
    v_mfma_f32_32x32x16_bf16 v[16:31], v[48:51], v[52:55], v[16:31]
    ds_read_b128 v[40:43], v2 offset:10240
    ds_read_b128 v[44:47], v4 offset:41984
    s_waitcnt lgkmcnt(4)
    v_mfma_f32_32x32x16_bf16 v[16:31], v[56:59], v[60:63], v[16:31]
    ds_read_b128 v[48:51], v2 offset:12288
    ds_read_b128 v[52:55], v4 offset:43008
    s_waitcnt lgkmcnt(4)
    v_mfma_f32_32x32x16_bf16 v[16:31], v[32:35], v[36:39], v[16:31]
    ds_read_b128 v[56:59], v2 offset:14336
    ds_read_b128 v[60:63], v4 offset:44032
    s_waitcnt lgkmcnt(4)
    v_mfma_f32_32x32x16_bf16 v[16:31], v[40:43], v[44:47], v[16:31]
    s_barrier
    ds_read_b128 v[32:35], v2 offset:16384
    ds_read_b128 v[36:39], v4 offset:0
    s_waitcnt lgkmcnt(4)
    v_mfma_f32_32x32x16_bf16 v[16:31], v[48:51], v[52:55], v[16:31]
    ds_read_b128 v[40:43], v2 offset:18432
    ds_read_b128 v[44:47], v4 offset:1024
    s_waitcnt lgkmcnt(4)
    v_mfma_f32_32x32x16_bf16 v[16:31], v[56:59], v[60:63], v[16:31]
    ds_read_b128 v[48:51], v2 offset:20480
    ds_read_b128 v[52:55], v4 offset:2048
    s_waitcnt lgkmcnt(4)
    v_mfma_f32_32x32x16_bf16 v[16:31], v[32:35], v[36:39], v[16:31]
    ds_read_b128 v[56:59], v2 offset:22528
    ds_read_b128 v[60:63], v4 offset:3072
    s_waitcnt lgkmcnt(4)
    v_mfma_f32_32x32x16_bf16 v[16:31], v[40:43], v[44:47], v[16:31]
    s_barrier
    ds_read_b128 v[32:35], v2 offset:24576
    ds_read_b128 v[36:39], v4 offset:8192
    s_waitcnt lgkmcnt(4)
    v_mfma_f32_32x32x16_bf16 v[16:31], v[48:51], v[52:55], v[16:31]
    ds_read_b128 v[40:43], v2 offset:26624
    ds_read_b128 v[44:47], v4 offset:9216
    s_waitcnt lgkmcnt(4)
    v_mfma_f32_32x32x16_bf16 v[16:31], v[56:59], v[60:63], v[16:31]
    ds_read_b128 v[48:51], v2 offset:28672
    ds_read_b128 v[52:55], v4 offset:10240
    s_waitcnt lgkmcnt(4)
    v_mfma_f32_32x32x16_bf16 v[16:31], v[32:35], v[36:39], v[16:31]
    ds_read_b128 v[56:59], v2 offset:30720
    ds_read_b128 v[60:63], v4 offset:11264
    s_waitcnt lgkmcnt(4)
    v_mfma_f32_32x32x16_bf16 v[16:31], v[40:43], v[44:47], v[16:31]
    s_barrier
    ds_read_b128 v[32:35], v2 offset:32768
    ds_read_b128 v[36:39], v4 offset:16384
    s_waitcnt lgkmcnt(4)
    v_mfma_f32_32x32x16_bf16 v[16:31], v[48:51], v[52:55], v[16:31]
    ds_read_b128 v[40:43], v2 offset:34816
    ds_read_b128 v[44:47], v4 offset:17408
    s_waitcnt lgkmcnt(4)
    v_mfma_f32_32x32x16_bf16 v[16:31], v[56:59], v[60:63], v[16:31]
    ds_read_b128 v[48:51], v2 offset:36864
    ds_read_b128 v[52:55], v4 offset:18432
    s_waitcnt lgkmcnt(4)
    v_mfma_f32_32x32x16_bf16 v[16:31], v[32:35], v[36:39], v[16:31]
    ds_read_b128 v[56:59], v2 offset:38912
    ds_read_b128 v[60:63], v4 offset:19456
    s_waitcnt lgkmcnt(4)
    v_mfma_f32_32x32x16_bf16 v[16:31], v[40:43], v[44:47], v[16:31]
    s_barrier
    ds_read_b128 v[32:35], v3 offset:0
    ds_read_b128 v[36:39], v4 offset:24576
    s_waitcnt lgkmcnt(4)
    v_mfma_f32_32x32x16_bf16 v[16:31], v[48:51], v[52:55], v[16:31]
    ds_read_b128 v[40:43], v3 offset:2048
    ds_read_b128 v[44:47], v4 offset:25600
    s_waitcnt lgkmcnt(4)
    v_mfma_f32_32x32x16_bf16 v[16:31], v[56:59], v[60:63], v[16:31]
    ds_read_b128 v[48:51], v3 offset:4096
    ds_read_b128 v[52:55], v4 offset:26624
    s_waitcnt lgkmcnt(4)
    v_mfma_f32_32x32x16_bf16 v[16:31], v[32:35], v[36:39], v[16:31]
    ds_read_b128 v[56:59], v3 offset:6144
    ds_read_b128 v[60:63], v4 offset:27648
    s_waitcnt lgkmcnt(4)
    v_mfma_f32_32x32x16_bf16 v[16:31], v[40:43], v[44:47], v[16:31]
    s_barrier
    ds_read_b128 v[32:35], v3 offset:8192
    ds_read_b128 v[36:39], v4 offset:32768
    s_waitcnt lgkmcnt(4)
    v_mfma_f32_32x32x16_bf16 v[16:31], v[48:51], v[52:55], v[16:31]
    ds_read_b128 v[40:43], v3 offset:10240
    ds_read_b128 v[44:47], v4 offset:33792
    s_waitcnt lgkmcnt(4)
    v_mfma_f32_32x32x16_bf16 v[16:31], v[56:59], v[60:63], v[16:31]
    ds_read_b128 v[48:51], v3 offset:12288
    ds_read_b128 v[52:55], v4 offset:34816
    s_waitcnt lgkmcnt(4)
    v_mfma_f32_32x32x16_bf16 v[16:31], v[32:35], v[36:39], v[16:31]
    ds_read_b128 v[56:59], v3 offset:14336
    ds_read_b128 v[60:63], v4 offset:35840
    s_waitcnt lgkmcnt(4)
    v_mfma_f32_32x32x16_bf16 v[16:31], v[40:43], v[44:47], v[16:31]
    s_barrier
    ds_read_b128 v[32:35], v3 offset:16384
    ds_read_b128 v[36:39], v4 offset:40960
    s_waitcnt lgkmcnt(4)
    v_mfma_f32_32x32x16_bf16 v[16:31], v[48:51], v[52:55], v[16:31]
    ds_read_b128 v[40:43], v3 offset:18432
    ds_read_b128 v[44:47], v4 offset:41984
    s_waitcnt lgkmcnt(4)
    v_mfma_f32_32x32x16_bf16 v[16:31], v[56:59], v[60:63], v[16:31]
    ds_read_b128 v[48:51], v3 offset:20480
    ds_read_b128 v[52:55], v4 offset:43008
    s_waitcnt lgkmcnt(4)
    v_mfma_f32_32x32x16_bf16 v[16:31], v[32:35], v[36:39], v[16:31]
    ds_read_b128 v[56:59], v3 offset:22528
    ds_read_b128 v[60:63], v4 offset:44032
    s_waitcnt lgkmcnt(4)
    v_mfma_f32_32x32x16_bf16 v[16:31], v[40:43], v[44:47], v[16:31]
    s_barrier
    ds_read_b128 v[32:35], v3 offset:24576
    ds_read_b128 v[36:39], v4 offset:0
    s_waitcnt lgkmcnt(4)
    v_mfma_f32_32x32x16_bf16 v[16:31], v[48:51], v[52:55], v[16:31]
    ds_read_b128 v[40:43], v3 offset:26624
    ds_read_b128 v[44:47], v4 offset:1024
    s_waitcnt lgkmcnt(4)
    v_mfma_f32_32x32x16_bf16 v[16:31], v[56:59], v[60:63], v[16:31]
    ds_read_b128 v[48:51], v3 offset:28672
    ds_read_b128 v[52:55], v4 offset:2048
    s_waitcnt lgkmcnt(4)
    v_mfma_f32_32x32x16_bf16 v[16:31], v[32:35], v[36:39], v[16:31]
    ds_read_b128 v[56:59], v3 offset:30720
    ds_read_b128 v[60:63], v4 offset:3072
    s_waitcnt lgkmcnt(4)
    v_mfma_f32_32x32x16_bf16 v[16:31], v[40:43], v[44:47], v[16:31]
    s_barrier
    ds_read_b128 v[32:35], v3 offset:32768
    ds_read_b128 v[36:39], v4 offset:8192
    s_waitcnt lgkmcnt(4)
    v_mfma_f32_32x32x16_bf16 v[16:31], v[48:51], v[52:55], v[16:31]
    ds_read_b128 v[40:43], v3 offset:34816
    ds_read_b128 v[44:47], v4 offset:9216
    s_waitcnt lgkmcnt(4)
    v_mfma_f32_32x32x16_bf16 v[16:31], v[56:59], v[60:63], v[16:31]
    ds_read_b128 v[48:51], v3 offset:36864
    ds_read_b128 v[52:55], v4 offset:10240
    s_waitcnt lgkmcnt(4)
    v_mfma_f32_32x32x16_bf16 v[16:31], v[32:35], v[36:39], v[16:31]
    ds_read_b128 v[56:59], v3 offset:38912
    ds_read_b128 v[60:63], v4 offset:11264
    s_waitcnt lgkmcnt(4)
    v_mfma_f32_32x32x16_bf16 v[16:31], v[40:43], v[44:47], v[16:31]
    s_barrier
    ds_read_b128 v[32:35], v2 offset:0
    ds_read_b128 v[36:39], v4 offset:16384
    s_waitcnt lgkmcnt(4)
    v_mfma_f32_32x32x16_bf16 v[16:31], v[48:51], v[52:55], v[16:31]
    ds_read_b128 v[40:43], v2 offset:2048
    ds_read_b128 v[44:47], v4 offset:17408
    s_waitcnt lgkmcnt(4)
    v_mfma_f32_32x32x16_bf16 v[16:31], v[56:59], v[60:63], v[16:31]
    ds_read_b128 v[48:51], v2 offset:4096
    ds_read_b128 v[52:55], v4 offset:18432
    s_waitcnt lgkmcnt(4)
    v_mfma_f32_32x32x16_bf16 v[16:31], v[32:35], v[36:39], v[16:31]
    ds_read_b128 v[56:59], v2 offset:6144
    ds_read_b128 v[60:63], v4 offset:19456
    s_waitcnt lgkmcnt(4)
    v_mfma_f32_32x32x16_bf16 v[16:31], v[40:43], v[44:47], v[16:31]
    s_barrier
    ds_read_b128 v[32:35], v2 offset:8192
    ds_read_b128 v[36:39], v4 offset:24576
    s_waitcnt lgkmcnt(4)
    v_mfma_f32_32x32x16_bf16 v[16:31], v[48:51], v[52:55], v[16:31]
    ds_read_b128 v[40:43], v2 offset:10240
    ds_read_b128 v[44:47], v4 offset:25600
    s_waitcnt lgkmcnt(4)
    v_mfma_f32_32x32x16_bf16 v[16:31], v[56:59], v[60:63], v[16:31]
    ds_read_b128 v[48:51], v2 offset:12288
    ds_read_b128 v[52:55], v4 offset:26624
    s_waitcnt lgkmcnt(4)
    v_mfma_f32_32x32x16_bf16 v[16:31], v[32:35], v[36:39], v[16:31]
    ds_read_b128 v[56:59], v2 offset:14336
    ds_read_b128 v[60:63], v4 offset:27648
    s_waitcnt lgkmcnt(4)
    v_mfma_f32_32x32x16_bf16 v[16:31], v[40:43], v[44:47], v[16:31]
    s_barrier
    ds_read_b128 v[32:35], v2 offset:16384
    ds_read_b128 v[36:39], v4 offset:32768
    s_waitcnt lgkmcnt(4)
    v_mfma_f32_32x32x16_bf16 v[16:31], v[48:51], v[52:55], v[16:31]
    ds_read_b128 v[40:43], v2 offset:18432
    ds_read_b128 v[44:47], v4 offset:33792
    s_waitcnt lgkmcnt(4)
    v_mfma_f32_32x32x16_bf16 v[16:31], v[56:59], v[60:63], v[16:31]
    ds_read_b128 v[48:51], v2 offset:20480
    ds_read_b128 v[52:55], v4 offset:34816
    s_waitcnt lgkmcnt(4)
    v_mfma_f32_32x32x16_bf16 v[16:31], v[32:35], v[36:39], v[16:31]
    ds_read_b128 v[56:59], v2 offset:22528
    ds_read_b128 v[60:63], v4 offset:35840
    s_waitcnt lgkmcnt(4)
    v_mfma_f32_32x32x16_bf16 v[16:31], v[40:43], v[44:47], v[16:31]
    s_barrier
    ds_read_b128 v[32:35], v2 offset:24576
    ds_read_b128 v[36:39], v4 offset:40960
    s_waitcnt lgkmcnt(4)
    v_mfma_f32_32x32x16_bf16 v[16:31], v[48:51], v[52:55], v[16:31]
    ds_read_b128 v[40:43], v2 offset:26624
    ds_read_b128 v[44:47], v4 offset:41984
    s_waitcnt lgkmcnt(4)
    v_mfma_f32_32x32x16_bf16 v[16:31], v[56:59], v[60:63], v[16:31]
    ds_read_b128 v[48:51], v2 offset:28672
    ds_read_b128 v[52:55], v4 offset:43008
    s_waitcnt lgkmcnt(4)
    v_mfma_f32_32x32x16_bf16 v[16:31], v[32:35], v[36:39], v[16:31]
    ds_read_b128 v[56:59], v2 offset:30720
    ds_read_b128 v[60:63], v4 offset:44032
    s_waitcnt lgkmcnt(4)
    v_mfma_f32_32x32x16_bf16 v[16:31], v[40:43], v[44:47], v[16:31]
    s_barrier
    ds_read_b128 v[32:35], v2 offset:32768
    ds_read_b128 v[36:39], v4 offset:0
    s_waitcnt lgkmcnt(4)
    v_mfma_f32_32x32x16_bf16 v[16:31], v[48:51], v[52:55], v[16:31]
    ds_read_b128 v[40:43], v2 offset:34816
    ds_read_b128 v[44:47], v4 offset:1024
    s_waitcnt lgkmcnt(4)
    v_mfma_f32_32x32x16_bf16 v[16:31], v[56:59], v[60:63], v[16:31]
    ds_read_b128 v[48:51], v2 offset:36864
    ds_read_b128 v[52:55], v4 offset:2048
    s_waitcnt lgkmcnt(4)
    v_mfma_f32_32x32x16_bf16 v[16:31], v[32:35], v[36:39], v[16:31]
    ds_read_b128 v[56:59], v2 offset:38912
    ds_read_b128 v[60:63], v4 offset:3072
    s_waitcnt lgkmcnt(4)
    v_mfma_f32_32x32x16_bf16 v[16:31], v[40:43], v[44:47], v[16:31]
    s_barrier
    ds_read_b128 v[32:35], v3 offset:0
    ds_read_b128 v[36:39], v4 offset:8192
    s_waitcnt lgkmcnt(4)
    v_mfma_f32_32x32x16_bf16 v[16:31], v[48:51], v[52:55], v[16:31]
    ds_read_b128 v[40:43], v3 offset:2048
    ds_read_b128 v[44:47], v4 offset:9216
    s_waitcnt lgkmcnt(4)
    v_mfma_f32_32x32x16_bf16 v[16:31], v[56:59], v[60:63], v[16:31]
    ds_read_b128 v[48:51], v3 offset:4096
    ds_read_b128 v[52:55], v4 offset:10240
    s_waitcnt lgkmcnt(4)
    v_mfma_f32_32x32x16_bf16 v[16:31], v[32:35], v[36:39], v[16:31]
    ds_read_b128 v[56:59], v3 offset:6144
    ds_read_b128 v[60:63], v4 offset:11264
    s_waitcnt lgkmcnt(4)
    v_mfma_f32_32x32x16_bf16 v[16:31], v[40:43], v[44:47], v[16:31]
    s_barrier
    ds_read_b128 v[32:35], v3 offset:8192
    ds_read_b128 v[36:39], v4 offset:16384
    s_waitcnt lgkmcnt(4)
    v_mfma_f32_32x32x16_bf16 v[16:31], v[48:51], v[52:55], v[16:31]
    ds_read_b128 v[40:43], v3 offset:10240
    ds_read_b128 v[44:47], v4 offset:17408
    s_waitcnt lgkmcnt(4)
    v_mfma_f32_32x32x16_bf16 v[16:31], v[56:59], v[60:63], v[16:31]
    ds_read_b128 v[48:51], v3 offset:12288
    ds_read_b128 v[52:55], v4 offset:18432
    s_waitcnt lgkmcnt(4)
    v_mfma_f32_32x32x16_bf16 v[16:31], v[32:35], v[36:39], v[16:31]
    ds_read_b128 v[56:59], v3 offset:14336
    ds_read_b128 v[60:63], v4 offset:19456
    s_waitcnt lgkmcnt(4)
    v_mfma_f32_32x32x16_bf16 v[16:31], v[40:43], v[44:47], v[16:31]
    s_barrier
    ds_read_b128 v[32:35], v3 offset:16384
    ds_read_b128 v[36:39], v4 offset:24576
    s_waitcnt lgkmcnt(4)
    v_mfma_f32_32x32x16_bf16 v[16:31], v[48:51], v[52:55], v[16:31]
    ds_read_b128 v[40:43], v3 offset:18432
    ds_read_b128 v[44:47], v4 offset:25600
    s_waitcnt lgkmcnt(4)
    v_mfma_f32_32x32x16_bf16 v[16:31], v[56:59], v[60:63], v[16:31]
    ds_read_b128 v[48:51], v3 offset:20480
    ds_read_b128 v[52:55], v4 offset:26624
    s_waitcnt lgkmcnt(4)
    v_mfma_f32_32x32x16_bf16 v[16:31], v[32:35], v[36:39], v[16:31]
    ds_read_b128 v[56:59], v3 offset:22528
    ds_read_b128 v[60:63], v4 offset:27648
    s_waitcnt lgkmcnt(4)
    v_mfma_f32_32x32x16_bf16 v[16:31], v[40:43], v[44:47], v[16:31]
    s_waitcnt lgkmcnt(2)
    v_mfma_f32_32x32x16_bf16 v[16:31], v[48:51], v[52:55], v[16:31]
    s_waitcnt lgkmcnt(0)
    v_mfma_f32_32x32x16_bf16 v[16:31], v[56:59], v[60:63], v[16:31]
    s_waitcnt vmcnt(0)
    s_cmp_ge_u32 s41, 4
    s_cbranch_scc1 .L_k4_up2
    v_alignbit_b32 v64, v98, v97, 16
    v_alignbit_b32 v65, v99, v98, 16
    v_alignbit_b32 v66, v100, v99, 16
    v_alignbit_b32 v67, v101, v100, 16
    v_alignbit_b32 v68, v102, v101, 16
    v_alignbit_b32 v69, v103, v102, 16
    v_alignbit_b32 v70, v104, v103, 16
    v_alignbit_b32 v71, v105, v104, 16
    s_branch .L_k4_j2
.L_k4_up2:
    v_mov_b32 v64, v98
    v_mov_b32 v65, v99
    v_mov_b32 v66, v100
    v_mov_b32 v67, v101
    v_mov_b32 v68, v102
    v_mov_b32 v69, v103
    v_mov_b32 v70, v104
    v_mov_b32 v71, v105
.L_k4_j2:
    v_lshlrev_b32 v96, 16, v64
    v_and_b32 v97, s30, v64
    v_lshlrev_b32 v98, 16, v65
    v_and_b32 v99, s30, v65
    v_lshlrev_b32 v100, 16, v66
    v_and_b32 v101, s30, v66
    v_lshlrev_b32 v102, 16, v67
    v_and_b32 v103, s30, v67
    v_lshlrev_b32 v104, 16, v68
    v_and_b32 v105, s30, v68
    v_lshlrev_b32 v106, 16, v69
    v_and_b32 v107, s30, v69
    v_lshlrev_b32 v108, 16, v70
    v_and_b32 v109, s30, v70
    v_lshlrev_b32 v110, 16, v71
    v_and_b32 v111, s30, v71
    v_add_f32 v16, v16, v96
    v_add_f32 v17, v17, v97
    v_add_f32 v18, v18, v98
    v_add_f32 v19, v19, v99
    v_add_f32 v20, v20, v100
    v_add_f32 v21, v21, v101
    v_add_f32 v22, v22, v102
    v_add_f32 v23, v23, v103
    v_add_f32 v24, v24, v104
    v_add_f32 v25, v25, v105
    v_add_f32 v26, v26, v106
    v_add_f32 v27, v27, v107
    v_add_f32 v28, v28, v108
    v_add_f32 v29, v29, v109
    v_add_f32 v30, v30, v110
    v_add_f32 v31, v31, v111
    v_cvt_pk_bf16_f32 v64, v16, v17
    v_cvt_pk_bf16_f32 v65, v18, v19
    v_cvt_pk_bf16_f32 v66, v20, v21
    v_cvt_pk_bf16_f32 v67, v22, v23
    v_cvt_pk_bf16_f32 v68, v24, v25
    v_cvt_pk_bf16_f32 v69, v26, v27
    v_cvt_pk_bf16_f32 v70, v28, v29
    v_cvt_pk_bf16_f32 v71, v30, v31
    global_store_dwordx4 v6, v[64:67], s[32:33]
    global_store_dwordx4 v6, v[68:71], s[32:33] offset:16
    s_endpgm
.L_k3_prod:
    s_and_b32 s15, s2, 7
    s_lshr_b32 s16, s2, 3
    s_and_b32 s17, s15, 1
    s_lshl_b32 s17, s17, 3
    s_and_b32 s18, s16, 7
    s_add_u32 s40, s17, s18
    s_lshr_b32 s18, s15, 1
    s_lshl_b32 s18, s18, 2
    s_lshr_b32 s19, s16, 3
    s_add_u32 s18, s18, s19
    s_and_b32 s24, s14, 3
    s_lshl_b32 s17, s40, 2
    s_add_u32 s17, s17, s24
    s_and_b32 s41, s15, 1
    s_lshl_b32 s41, s41, 2
    s_and_b32 s19, s16, 3
    s_add_u32 s41, s41, s19
    s_lshr_b32 s42, s15, 1
    s_lshl_b32 s42, s42, 3
    s_lshr_b32 s19, s16, 2
    s_add_u32 s42, s42, s19
    s_lshl_b32 s19, s17, 15
    s_add_u32 s19, s19, 2097152
    s_mul_i32 s20, s18, 229376
    s_add_u32 s20, s20, 4194304
    s_lshl_b32 s21, s24, 10
    s_add_u32 s20, s20, s21
    s_waitcnt lgkmcnt(0)
    s_add_u32 s4, s12, s19
    s_addc_u32 s5, s13, 0
    s_add_u32 s6, s12, s20
    s_addc_u32 s7, s13, 0
    s_add_u32 s8, s12, 7864320
    s_addc_u32 s9, s13, 0
    s_min_u32 s25, s24, 1
    s_lshl_b32 s26, s25, 10
    s_sub_u32 s25, s20, s21
    s_add_u32 s25, s25, s26
    s_add_u32 s25, s25, 12288
    s_add_u32 s10, s12, s25
    s_addc_u32 s11, s13, 0
    v_mov_b32 v33, 163764
    s_mov_b32 s39, 0
.wl_k3_kernel_5:
    ds_read_b32 v32, v33
    s_waitcnt lgkmcnt(0)
    v_readfirstlane_b32 s38, v32
    s_add_u32 s39, s39, 1
    s_cmp_ge_u32 s38, 4
    s_cbranch_scc1 .wld_k3_kernel_6
    s_cmp_ge_u32 s39, 1600000
    s_cbranch_scc1 .wld_k3_kernel_6
    s_sleep 2
    s_branch .wl_k3_kernel_5
.wld_k3_kernel_6:
    s_add_u32 m0, s21, 0
    s_nop 0
    global_load_lds_dwordx4 v1, s[6:7]
    s_add_u32 s6, s6, 4096
    s_addc_u32 s7, s7, 0
    s_add_u32 m0, s21, 4096
    s_nop 0
    global_load_lds_dwordx4 v1, s[6:7]
    s_add_u32 s6, s6, 4096
    s_addc_u32 s7, s7, 0
    s_add_u32 m0, s21, 8192
    s_nop 0
    global_load_lds_dwordx4 v1, s[6:7]
    s_add_u32 s6, s6, 4096
    s_addc_u32 s7, s7, 0
    s_add_u32 m0, s26, 12288
    s_nop 0
    global_load_lds_dwordx4 v1, s[10:11]
    s_add_u32 s6, s6, 2048
    s_addc_u32 s7, s7, 0
    s_add_u32 s10, s10, 14336
    s_addc_u32 s11, s11, 0
    s_add_u32 m0, s21, 22528
    s_nop 0
    global_load_lds_dwordx4 v1, s[6:7]
    s_add_u32 s6, s6, 4096
    s_addc_u32 s7, s7, 0
    s_add_u32 m0, s21, 26624
    s_nop 0
    global_load_lds_dwordx4 v1, s[6:7]
    s_add_u32 s6, s6, 4096
    s_addc_u32 s7, s7, 0
    s_add_u32 m0, s21, 30720
    s_nop 0
    global_load_lds_dwordx4 v1, s[6:7]
    s_add_u32 s6, s6, 4096
    s_addc_u32 s7, s7, 0
    s_add_u32 m0, s26, 34816
    s_nop 0
    global_load_lds_dwordx4 v1, s[10:11]
    s_add_u32 s6, s6, 2048
    s_addc_u32 s7, s7, 0
    s_add_u32 s10, s10, 14336
    s_addc_u32 s11, s11, 0
    s_add_u32 m0, s21, 45056
    s_nop 0
    global_load_lds_dwordx4 v1, s[6:7]
    s_add_u32 s6, s6, 4096
    s_addc_u32 s7, s7, 0
    s_add_u32 m0, s21, 49152
    s_nop 0
    global_load_lds_dwordx4 v1, s[6:7]
    s_add_u32 s6, s6, 4096
    s_addc_u32 s7, s7, 0
    s_add_u32 m0, s21, 53248
    s_nop 0
    global_load_lds_dwordx4 v1, s[6:7]
    s_add_u32 s6, s6, 4096
    s_addc_u32 s7, s7, 0
    s_add_u32 m0, s26, 57344
    s_nop 0
    global_load_lds_dwordx4 v1, s[10:11]
    s_add_u32 s6, s6, 2048
    s_addc_u32 s7, s7, 0
    s_add_u32 s10, s10, 14336
    s_addc_u32 s11, s11, 0
    s_add_u32 m0, s21, 67584
    s_nop 0
    global_load_lds_dwordx4 v1, s[6:7]
    s_add_u32 s6, s6, 4096
    s_addc_u32 s7, s7, 0
    s_add_u32 m0, s21, 71680
    s_nop 0
    global_load_lds_dwordx4 v1, s[6:7]
    s_add_u32 s6, s6, 4096
    s_addc_u32 s7, s7, 0
    s_add_u32 m0, s21, 75776
    s_nop 0
    global_load_lds_dwordx4 v1, s[6:7]
    s_add_u32 s6, s6, 4096
    s_addc_u32 s7, s7, 0
    s_add_u32 m0, s26, 79872
    s_nop 0
    global_load_lds_dwordx4 v1, s[10:11]
    s_add_u32 s6, s6, 2048
    s_addc_u32 s7, s7, 0
    s_add_u32 s10, s10, 14336
    s_addc_u32 s11, s11, 0
    s_add_u32 m0, s21, 90112
    s_nop 0
    global_load_lds_dwordx4 v1, s[6:7]
    s_add_u32 s6, s6, 4096
    s_addc_u32 s7, s7, 0
    s_add_u32 m0, s21, 94208
    s_nop 0
    global_load_lds_dwordx4 v1, s[6:7]
    s_add_u32 s6, s6, 4096
    s_addc_u32 s7, s7, 0
    s_add_u32 m0, s21, 98304
    s_nop 0
    global_load_lds_dwordx4 v1, s[6:7]
    s_add_u32 s6, s6, 4096
    s_addc_u32 s7, s7, 0
    s_add_u32 m0, s26, 102400
    s_nop 0
    global_load_lds_dwordx4 v1, s[10:11]
    s_add_u32 s6, s6, 2048
    s_addc_u32 s7, s7, 0
    s_add_u32 s10, s10, 14336
    s_addc_u32 s11, s11, 0
    s_add_u32 m0, s21, 112640
    s_nop 0
    global_load_lds_dwordx4 v1, s[6:7]
    s_add_u32 s6, s6, 4096
    s_addc_u32 s7, s7, 0
    s_add_u32 m0, s21, 116736
    s_nop 0
    global_load_lds_dwordx4 v1, s[6:7]
    s_add_u32 s6, s6, 4096
    s_addc_u32 s7, s7, 0
    s_add_u32 m0, s21, 120832
    s_nop 0
    global_load_lds_dwordx4 v1, s[6:7]
    s_add_u32 s6, s6, 4096
    s_addc_u32 s7, s7, 0
    s_add_u32 m0, s26, 124928
    s_nop 0
    global_load_lds_dwordx4 v1, s[10:11]
    s_add_u32 s6, s6, 2048
    s_addc_u32 s7, s7, 0
    s_add_u32 s10, s10, 14336
    s_addc_u32 s11, s11, 0
    s_waitcnt vmcnt(0)
    v_mov_b32 v33, 163720
    s_mov_b32 s39, 0
.own_k3_kernel_7:
    ds_read_b32 v32, v33
    s_waitcnt lgkmcnt(0)
    v_readfirstlane_b32 s38, v32
    s_add_u32 s39, s39, 1
    s_cmp_ge_u32 s38, 4
    s_cbranch_scc1 .ownd_k3_kernel_8
    s_cmp_ge_u32 s39, 1600000
    s_cbranch_scc1 .ownd_k3_kernel_8
    s_sleep 2
    s_branch .own_k3_kernel_7
.ownd_k3_kernel_8:
    s_bfe_u32 s43, s40, 0x20001
    s_lshl_b32 s43, s43, 12
    s_add_u32 s43, s43, 18890752
    v_and_b32 v34, 63, v0
    v_min_u32 v34, 15, v34
    v_lshlrev_b32 v34, 8, v34
    v_add_u32 v34, s43, v34
    v_mov_b32 v33, 163724
    s_mov_b32 s47, 0
    s_cmp_ge_u32 s47, 1
    s_cbranch_scc1 .ere_k3_kernel_11
    s_mov_b32 s39, 0
    v_mov_b32 v33, 163724
    s_cmp_lg_u32 s24, 0
    s_cbranch_scc1 .erl_k3_kernel_10
.er_k3_kernel_9:
    global_load_dword v32, v34, s[12:13] sc1
    s_waitcnt vmcnt(0)
    v_cmp_gt_u32 vcc, 4, v32
    s_nop 3
    s_or_b32 s38, vcc_lo, 0x10000
    s_ff1_i32_b32 s47, s38
    v_mov_b32 v32, s47
    ds_write_b32 v33, v32
    s_add_u32 s39, s39, 1
    s_cmp_ge_u32 s47, 1
    s_cbranch_scc1 .ere_k3_kernel_11
    s_cmp_ge_u32 s39, 200000
    s_cbranch_scc1 .ere_k3_kernel_11
    s_sleep 4
    s_branch .er_k3_kernel_9
.erl_k3_kernel_10:
    ds_read_b32 v32, v33
    s_waitcnt lgkmcnt(0)
    v_readfirstlane_b32 s47, v32
    s_add_u32 s39, s39, 1
    s_cmp_ge_u32 s47, 1
    s_cbranch_scc1 .ere_k3_kernel_11
    s_cmp_ge_u32 s39, 1600000
    s_cbranch_scc1 .ere_k3_kernel_11
    s_sleep 2
    s_branch .erl_k3_kernel_10
.ere_k3_kernel_11:
    s_add_u32 m0, s21, 14336
    s_nop 0
    global_load_lds_dwordx4 v1, s[4:5] sc1
    s_add_u32 s4, s4, 1024
    s_addc_u32 s5, s5, 0
    s_add_u32 m0, s21, 18432
    s_nop 0
    global_load_lds_dwordx4 v1, s[4:5] sc1
    s_add_u32 s4, s4, 1024
    s_addc_u32 s5, s5, 0
    s_cmp_ge_u32 s47, 2
    s_cbranch_scc1 .ere_k3_kernel_14
    s_mov_b32 s39, 0
    v_mov_b32 v33, 163724
    s_cmp_lg_u32 s24, 0
    s_cbranch_scc1 .erl_k3_kernel_13
.er_k3_kernel_12:
    global_load_dword v32, v34, s[12:13] sc1
    s_waitcnt vmcnt(0)
    v_cmp_gt_u32 vcc, 4, v32
    s_nop 3
    s_or_b32 s38, vcc_lo, 0x10000
    s_ff1_i32_b32 s47, s38
    v_mov_b32 v32, s47
    ds_write_b32 v33, v32
    s_add_u32 s39, s39, 1
    s_cmp_ge_u32 s47, 2
    s_cbranch_scc1 .ere_k3_kernel_14
    s_cmp_ge_u32 s39, 200000
    s_cbranch_scc1 .ere_k3_kernel_14
    s_sleep 4
    s_branch .er_k3_kernel_12
.erl_k3_kernel_13:
    ds_read_b32 v32, v33
    s_waitcnt lgkmcnt(0)
    v_readfirstlane_b32 s47, v32
    s_add_u32 s39, s39, 1
    s_cmp_ge_u32 s47, 2
    s_cbranch_scc1 .ere_k3_kernel_14
    s_cmp_ge_u32 s39, 1600000
    s_cbranch_scc1 .ere_k3_kernel_14
    s_sleep 2
    s_branch .erl_k3_kernel_13
.ere_k3_kernel_14:
    s_add_u32 m0, s21, 36864
    s_nop 0
    global_load_lds_dwordx4 v1, s[4:5] sc1
    s_add_u32 s4, s4, 1024
    s_addc_u32 s5, s5, 0
    s_add_u32 m0, s21, 40960
    s_nop 0
    global_load_lds_dwordx4 v1, s[4:5] sc1
    s_add_u32 s4, s4, 1024
    s_addc_u32 s5, s5, 0
    s_cmp_ge_u32 s47, 3
    s_cbranch_scc1 .ere_k3_kernel_17
    s_mov_b32 s39, 0
    v_mov_b32 v33, 163724
    s_cmp_lg_u32 s24, 0
    s_cbranch_scc1 .erl_k3_kernel_16
.er_k3_kernel_15:
    global_load_dword v32, v34, s[12:13] sc1
    s_waitcnt vmcnt(0)
    v_cmp_gt_u32 vcc, 4, v32
    s_nop 3
    s_or_b32 s38, vcc_lo, 0x10000
    s_ff1_i32_b32 s47, s38
    v_mov_b32 v32, s47
    ds_write_b32 v33, v32
    s_add_u32 s39, s39, 1
    s_cmp_ge_u32 s47, 3
    s_cbranch_scc1 .ere_k3_kernel_17
    s_cmp_ge_u32 s39, 200000
    s_cbranch_scc1 .ere_k3_kernel_17
    s_sleep 4
    s_branch .er_k3_kernel_15
.erl_k3_kernel_16:
    ds_read_b32 v32, v33
    s_waitcnt lgkmcnt(0)
    v_readfirstlane_b32 s47, v32
    s_add_u32 s39, s39, 1
    s_cmp_ge_u32 s47, 3
    s_cbranch_scc1 .ere_k3_kernel_17
    s_cmp_ge_u32 s39, 1600000
    s_cbranch_scc1 .ere_k3_kernel_17
    s_sleep 2
    s_branch .erl_k3_kernel_16
.ere_k3_kernel_17:
    s_add_u32 m0, s21, 59392
    s_nop 0
    global_load_lds_dwordx4 v1, s[4:5] sc1
    s_add_u32 s4, s4, 1024
    s_addc_u32 s5, s5, 0
    s_add_u32 m0, s21, 63488
    s_nop 0
    global_load_lds_dwordx4 v1, s[4:5] sc1
    s_add_u32 s4, s4, 1024
    s_addc_u32 s5, s5, 0
    s_cmp_ge_u32 s47, 4
    s_cbranch_scc1 .ere_k3_kernel_20
    s_mov_b32 s39, 0
    v_mov_b32 v33, 163724
    s_cmp_lg_u32 s24, 0
    s_cbranch_scc1 .erl_k3_kernel_19
.er_k3_kernel_18:
    global_load_dword v32, v34, s[12:13] sc1
    s_waitcnt vmcnt(0)
    v_cmp_gt_u32 vcc, 4, v32
    s_nop 3
    s_or_b32 s38, vcc_lo, 0x10000
    s_ff1_i32_b32 s47, s38
    v_mov_b32 v32, s47
    ds_write_b32 v33, v32
    s_add_u32 s39, s39, 1
    s_cmp_ge_u32 s47, 4
    s_cbranch_scc1 .ere_k3_kernel_20
    s_cmp_ge_u32 s39, 200000
    s_cbranch_scc1 .ere_k3_kernel_20
    s_sleep 4
    s_branch .er_k3_kernel_18
.erl_k3_kernel_19:
    ds_read_b32 v32, v33
    s_waitcnt lgkmcnt(0)
    v_readfirstlane_b32 s47, v32
    s_add_u32 s39, s39, 1
    s_cmp_ge_u32 s47, 4
    s_cbranch_scc1 .ere_k3_kernel_20
    s_cmp_ge_u32 s39, 1600000
    s_cbranch_scc1 .ere_k3_kernel_20
    s_sleep 2
    s_branch .erl_k3_kernel_19
.ere_k3_kernel_20:
    s_add_u32 m0, s21, 81920
    s_nop 0
    global_load_lds_dwordx4 v1, s[4:5] sc1
    s_add_u32 s4, s4, 1024
    s_addc_u32 s5, s5, 0
    s_add_u32 m0, s21, 86016
    s_nop 0
    global_load_lds_dwordx4 v1, s[4:5] sc1
    s_add_u32 s4, s4, 1024
    s_addc_u32 s5, s5, 0
    s_cmp_ge_u32 s47, 5
    s_cbranch_scc1 .ere_k3_kernel_23
    s_mov_b32 s39, 0
    v_mov_b32 v33, 163724
    s_cmp_lg_u32 s24, 0
    s_cbranch_scc1 .erl_k3_kernel_22
.er_k3_kernel_21:
    global_load_dword v32, v34, s[12:13] sc1
    s_waitcnt vmcnt(0)
    v_cmp_gt_u32 vcc, 4, v32
    s_nop 3
    s_or_b32 s38, vcc_lo, 0x10000
    s_ff1_i32_b32 s47, s38
    v_mov_b32 v32, s47
    ds_write_b32 v33, v32
    s_add_u32 s39, s39, 1
    s_cmp_ge_u32 s47, 5
    s_cbranch_scc1 .ere_k3_kernel_23
    s_cmp_ge_u32 s39, 200000
    s_cbranch_scc1 .ere_k3_kernel_23
    s_sleep 4
    s_branch .er_k3_kernel_21
.erl_k3_kernel_22:
    ds_read_b32 v32, v33
    s_waitcnt lgkmcnt(0)
    v_readfirstlane_b32 s47, v32
    s_add_u32 s39, s39, 1
    s_cmp_ge_u32 s47, 5
    s_cbranch_scc1 .ere_k3_kernel_23
    s_cmp_ge_u32 s39, 1600000
    s_cbranch_scc1 .ere_k3_kernel_23
    s_sleep 2
    s_branch .erl_k3_kernel_22
.ere_k3_kernel_23:
    s_add_u32 m0, s21, 104448
    s_nop 0
    global_load_lds_dwordx4 v1, s[4:5] sc1
    s_add_u32 s4, s4, 1024
    s_addc_u32 s5, s5, 0
    s_add_u32 m0, s21, 108544
    s_nop 0
    global_load_lds_dwordx4 v1, s[4:5] sc1
    s_add_u32 s4, s4, 1024
    s_addc_u32 s5, s5, 0
    s_cmp_ge_u32 s47, 6
    s_cbranch_scc1 .ere_k3_kernel_26
    s_mov_b32 s39, 0
    v_mov_b32 v33, 163724
    s_cmp_lg_u32 s24, 0
    s_cbranch_scc1 .erl_k3_kernel_25
.er_k3_kernel_24:
    global_load_dword v32, v34, s[12:13] sc1
    s_waitcnt vmcnt(0)
    v_cmp_gt_u32 vcc, 4, v32
    s_nop 3
    s_or_b32 s38, vcc_lo, 0x10000
    s_ff1_i32_b32 s47, s38
    v_mov_b32 v32, s47
    ds_write_b32 v33, v32
    s_add_u32 s39, s39, 1
    s_cmp_ge_u32 s47, 6
    s_cbranch_scc1 .ere_k3_kernel_26
    s_cmp_ge_u32 s39, 200000
    s_cbranch_scc1 .ere_k3_kernel_26
    s_sleep 4
    s_branch .er_k3_kernel_24
.erl_k3_kernel_25:
    ds_read_b32 v32, v33
    s_waitcnt lgkmcnt(0)
    v_readfirstlane_b32 s47, v32
    s_add_u32 s39, s39, 1
    s_cmp_ge_u32 s47, 6
    s_cbranch_scc1 .ere_k3_kernel_26
    s_cmp_ge_u32 s39, 1600000
    s_cbranch_scc1 .ere_k3_kernel_26
    s_sleep 2
    s_branch .erl_k3_kernel_25
.ere_k3_kernel_26:
    s_add_u32 m0, s21, 126976
    s_nop 0
    global_load_lds_dwordx4 v1, s[4:5] sc1
    s_add_u32 s4, s4, 1024
    s_addc_u32 s5, s5, 0
    s_add_u32 m0, s21, 131072
    s_nop 0
    global_load_lds_dwordx4 v1, s[4:5] sc1
    s_add_u32 s4, s4, 1024
    s_addc_u32 s5, s5, 0
    s_waitcnt vmcnt(10)
    s_barrier
    s_waitcnt vmcnt(8)
    s_barrier
    s_waitcnt vmcnt(6)
    s_barrier
    s_cmp_ge_u32 s47, 7
    s_cbranch_scc1 .ere_k3_kernel_29
    s_mov_b32 s39, 0
    v_mov_b32 v33, 163724
    s_cmp_lg_u32 s24, 0
    s_cbranch_scc1 .erl_k3_kernel_28
.er_k3_kernel_27:
    global_load_dword v32, v34, s[12:13] sc1
    s_waitcnt vmcnt(0)
    v_cmp_gt_u32 vcc, 4, v32
    s_nop 3
    s_or_b32 s38, vcc_lo, 0x10000
    s_ff1_i32_b32 s47, s38
    v_mov_b32 v32, s47
    ds_write_b32 v33, v32
    s_add_u32 s39, s39, 1
    s_cmp_ge_u32 s47, 7
    s_cbranch_scc1 .ere_k3_kernel_29
    s_cmp_ge_u32 s39, 200000
    s_cbranch_scc1 .ere_k3_kernel_29
    s_sleep 4
    s_branch .er_k3_kernel_27
.erl_k3_kernel_28:
    ds_read_b32 v32, v33
    s_waitcnt lgkmcnt(0)
    v_readfirstlane_b32 s47, v32
    s_add_u32 s39, s39, 1
    s_cmp_ge_u32 s47, 7
    s_cbranch_scc1 .ere_k3_kernel_29
    s_cmp_ge_u32 s39, 1600000
    s_cbranch_scc1 .ere_k3_kernel_29
    s_sleep 2
    s_branch .erl_k3_kernel_28
.ere_k3_kernel_29:
    s_add_u32 m0, s21, 14336
    s_nop 0
    global_load_lds_dwordx4 v1, s[4:5] sc1
    s_add_u32 s4, s4, 1024
    s_addc_u32 s5, s5, 0
    s_add_u32 m0, s21, 18432
    s_nop 0
    global_load_lds_dwordx4 v1, s[4:5] sc1
    s_add_u32 s4, s4, 1024
    s_addc_u32 s5, s5, 0
    s_add_u32 m0, s21, 0
    s_nop 0
    global_load_lds_dwordx4 v1, s[6:7]
    s_add_u32 s6, s6, 4096
    s_addc_u32 s7, s7, 0
    s_add_u32 m0, s21, 4096
    s_nop 0
    global_load_lds_dwordx4 v1, s[6:7]
    s_add_u32 s6, s6, 4096
    s_addc_u32 s7, s7, 0
    s_add_u32 m0, s21, 8192
    s_nop 0
    global_load_lds_dwordx4 v1, s[6:7]
    s_add_u32 s6, s6, 4096
    s_addc_u32 s7, s7, 0
    s_add_u32 m0, s26, 12288
    s_nop 0
    global_load_lds_dwordx4 v1, s[10:11]
    s_add_u32 s6, s6, 2048
    s_addc_u32 s7, s7, 0
    s_add_u32 s10, s10, 14336
    s_addc_u32 s11, s11, 0
    s_waitcnt vmcnt(10)
    s_barrier
    s_cmp_ge_u32 s47, 8
    s_cbranch_scc1 .ere_k3_kernel_32
    s_mov_b32 s39, 0
    v_mov_b32 v33, 163724
    s_cmp_lg_u32 s24, 0
    s_cbranch_scc1 .erl_k3_kernel_31
.er_k3_kernel_30:
    global_load_dword v32, v34, s[12:13] sc1
    s_waitcnt vmcnt(0)
    v_cmp_gt_u32 vcc, 4, v32
    s_nop 3
    s_or_b32 s38, vcc_lo, 0x10000
    s_ff1_i32_b32 s47, s38
    v_mov_b32 v32, s47
    ds_write_b32 v33, v32
    s_add_u32 s39, s39, 1
    s_cmp_ge_u32 s47, 8
    s_cbranch_scc1 .ere_k3_kernel_32
    s_cmp_ge_u32 s39, 200000
    s_cbranch_scc1 .ere_k3_kernel_32
    s_sleep 4
    s_branch .er_k3_kernel_30
.erl_k3_kernel_31:
    ds_read_b32 v32, v33
    s_waitcnt lgkmcnt(0)
    v_readfirstlane_b32 s47, v32
    s_add_u32 s39, s39, 1
    s_cmp_ge_u32 s47, 8
    s_cbranch_scc1 .ere_k3_kernel_32
    s_cmp_ge_u32 s39, 1600000
    s_cbranch_scc1 .ere_k3_kernel_32
    s_sleep 2
    s_branch .erl_k3_kernel_31
.ere_k3_kernel_32:
    s_add_u32 m0, s21, 36864
    s_nop 0
    global_load_lds_dwordx4 v1, s[4:5] sc1
    s_add_u32 s4, s4, 1024
    s_addc_u32 s5, s5, 0
    s_add_u32 m0, s21, 40960
    s_nop 0
    global_load_lds_dwordx4 v1, s[4:5] sc1
    s_add_u32 s4, s4, 1024
    s_addc_u32 s5, s5, 0
    s_add_u32 m0, s21, 22528
    s_nop 0
    global_load_lds_dwordx4 v1, s[6:7]
    s_add_u32 s6, s6, 4096
    s_addc_u32 s7, s7, 0
    s_add_u32 m0, s21, 26624
    s_nop 0
    global_load_lds_dwordx4 v1, s[6:7]
    s_add_u32 s6, s6, 4096
    s_addc_u32 s7, s7, 0
    s_add_u32 m0, s21, 30720
    s_nop 0
    global_load_lds_dwordx4 v1, s[6:7]
    s_add_u32 s6, s6, 4096
    s_addc_u32 s7, s7, 0
    s_add_u32 m0, s26, 34816
    s_nop 0
    global_load_lds_dwordx4 v1, s[10:11]
    s_add_u32 s6, s6, 2048
    s_addc_u32 s7, s7, 0
    s_add_u32 s10, s10, 14336
    s_addc_u32 s11, s11, 0
    v_subrev_u32 v10, 256, v0
    v_lshrrev_b32 v11, 5, v10
    v_min_u32 v11, 6, v11
    v_and_b32 v12, 31, v10
    v_lshl_add_u32 v13, v11, 5, v12
    s_mul_i32 s22, s18, 224
    v_add_u32 v13, s22, v13
    v_lshlrev_b32 v13, 2, v13
    v_bfe_u32 v14, v12, 2, 1
    v_lshl_add_u32 v14, v11, 1, v14
    v_lshlrev_b32 v14, 4, v14
    v_and_b32 v15, 3, v12
    v_add_u32 v14, v14, v15
    v_lshrrev_b32 v15, 3, v12
    v_lshl_add_u32 v14, v15, 2, v14
    v_lshlrev_b32 v14, 2, v14
    v_add_u32 v15, 162816, v14
    global_load_dword v16, v13, s[8:9]
    s_add_u32 s8, s8, 14336
    s_addc_u32 s9, s9, 0
    global_load_dword v17, v13, s[8:9]
    s_add_u32 s8, s8, 14336
    s_addc_u32 s9, s9, 0
    global_load_dword v18, v13, s[8:9]
    s_add_u32 s8, s8, 14336
    s_addc_u32 s9, s9, 0
    global_load_dword v19, v13, s[8:9]
    s_add_u32 s8, s8, 14336
    s_addc_u32 s9, s9, 0
    global_load_dword v20, v13, s[8:9]
    s_add_u32 s8, s8, 14336
    s_addc_u32 s9, s9, 0
    global_load_dword v21, v13, s[8:9]
    s_add_u32 s8, s8, 14336
    s_addc_u32 s9, s9, 0
    global_load_dword v22, v13, s[8:9]
    s_add_u32 s8, s8, 14336
    s_addc_u32 s9, s9, 0
    global_load_dword v23, v13, s[8:9]
    s_add_u32 s8, s8, 14336
    s_addc_u32 s9, s9, 0
    global_load_dword v24, v13, s[8:9]
    s_add_u32 s8, s8, 14336
    s_addc_u32 s9, s9, 0
    global_load_dword v25, v13, s[8:9]
    s_add_u32 s8, s8, 14336
    s_addc_u32 s9, s9, 0
    global_load_dword v26, v13, s[8:9]
    s_add_u32 s8, s8, 14336
    s_addc_u32 s9, s9, 0
    global_load_dword v27, v13, s[8:9]
    s_add_u32 s8, s8, 14336
    s_addc_u32 s9, s9, 0
    global_load_dword v28, v13, s[8:9]
    s_add_u32 s8, s8, 14336
    s_addc_u32 s9, s9, 0
    global_load_dword v29, v13, s[8:9]
    s_add_u32 s8, s8, 14336
    s_addc_u32 s9, s9, 0
    global_load_dword v30, v13, s[8:9]
    s_add_u32 s8, s8, 14336
    s_addc_u32 s9, s9, 0
    global_load_dword v31, v13, s[8:9]
    s_waitcnt vmcnt(30)
    s_barrier
    s_cmp_ge_u32 s47, 9
    s_cbranch_scc1 .ere_k3_kernel_35
    s_mov_b32 s39, 0
    v_mov_b32 v33, 163724
    s_cmp_lg_u32 s24, 0
    s_cbranch_scc1 .erl_k3_kernel_34
.er_k3_kernel_33:
    global_load_dword v32, v34, s[12:13] sc1
    s_waitcnt vmcnt(0)
    v_cmp_gt_u32 vcc, 4, v32
    s_nop 3
    s_or_b32 s38, vcc_lo, 0x10000
    s_ff1_i32_b32 s47, s38
    v_mov_b32 v32, s47
    ds_write_b32 v33, v32
    s_add_u32 s39, s39, 1
    s_cmp_ge_u32 s47, 9
    s_cbranch_scc1 .ere_k3_kernel_35
    s_cmp_ge_u32 s39, 200000
    s_cbranch_scc1 .ere_k3_kernel_35
    s_sleep 4
    s_branch .er_k3_kernel_33
.erl_k3_kernel_34:
    ds_read_b32 v32, v33
    s_waitcnt lgkmcnt(0)
    v_readfirstlane_b32 s47, v32
    s_add_u32 s39, s39, 1
    s_cmp_ge_u32 s47, 9
    s_cbranch_scc1 .ere_k3_kernel_35
    s_cmp_ge_u32 s39, 1600000
    s_cbranch_scc1 .ere_k3_kernel_35
    s_sleep 2
    s_branch .erl_k3_kernel_34
.ere_k3_kernel_35:
    s_add_u32 m0, s21, 59392
    s_nop 0
    global_load_lds_dwordx4 v1, s[4:5] sc1
    s_add_u32 s4, s4, 1024
    s_addc_u32 s5, s5, 0
    s_add_u32 m0, s21, 63488
    s_nop 0
    global_load_lds_dwordx4 v1, s[4:5] sc1
    s_add_u32 s4, s4, 1024
    s_addc_u32 s5, s5, 0
    s_add_u32 m0, s21, 45056
    s_nop 0
    global_load_lds_dwordx4 v1, s[6:7]
    s_add_u32 s6, s6, 4096
    s_addc_u32 s7, s7, 0
    s_add_u32 m0, s21, 49152
    s_nop 0
    global_load_lds_dwordx4 v1, s[6:7]
    s_add_u32 s6, s6, 4096
    s_addc_u32 s7, s7, 0
    s_add_u32 m0, s21, 53248
    s_nop 0
    global_load_lds_dwordx4 v1, s[6:7]
    s_add_u32 s6, s6, 4096
    s_addc_u32 s7, s7, 0
    s_add_u32 m0, s26, 57344
    s_nop 0
    global_load_lds_dwordx4 v1, s[10:11]
    s_add_u32 s6, s6, 2048
    s_addc_u32 s7, s7, 0
    s_add_u32 s10, s10, 14336
    s_addc_u32 s11, s11, 0
    s_waitcnt vmcnt(34)
    s_barrier
    s_cmp_ge_u32 s47, 10
    s_cbranch_scc1 .ere_k3_kernel_38
    s_mov_b32 s39, 0
    v_mov_b32 v33, 163724
    s_cmp_lg_u32 s24, 0
    s_cbranch_scc1 .erl_k3_kernel_37
.er_k3_kernel_36:
    global_load_dword v32, v34, s[12:13] sc1
    s_waitcnt vmcnt(0)
    v_cmp_gt_u32 vcc, 4, v32
    s_nop 3
    s_or_b32 s38, vcc_lo, 0x10000
    s_ff1_i32_b32 s47, s38
    v_mov_b32 v32, s47
    ds_write_b32 v33, v32
    s_add_u32 s39, s39, 1
    s_cmp_ge_u32 s47, 10
    s_cbranch_scc1 .ere_k3_kernel_38
    s_cmp_ge_u32 s39, 200000
    s_cbranch_scc1 .ere_k3_kernel_38
    s_sleep 4
    s_branch .er_k3_kernel_36
.erl_k3_kernel_37:
    ds_read_b32 v32, v33
    s_waitcnt lgkmcnt(0)
    v_readfirstlane_b32 s47, v32
    s_add_u32 s39, s39, 1
    s_cmp_ge_u32 s47, 10
    s_cbranch_scc1 .ere_k3_kernel_38
    s_cmp_ge_u32 s39, 1600000
    s_cbranch_scc1 .ere_k3_kernel_38
    s_sleep 2
    s_branch .erl_k3_kernel_37
.ere_k3_kernel_38:
    s_add_u32 m0, s21, 81920
    s_nop 0
    global_load_lds_dwordx4 v1, s[4:5] sc1
    s_add_u32 s4, s4, 1024
    s_addc_u32 s5, s5, 0
    s_add_u32 m0, s21, 86016
    s_nop 0
    global_load_lds_dwordx4 v1, s[4:5] sc1
    s_add_u32 s4, s4, 1024
    s_addc_u32 s5, s5, 0
    s_add_u32 m0, s21, 67584
    s_nop 0
    global_load_lds_dwordx4 v1, s[6:7]
    s_add_u32 s6, s6, 4096
    s_addc_u32 s7, s7, 0
    s_add_u32 m0, s21, 71680
    s_nop 0
    global_load_lds_dwordx4 v1, s[6:7]
    s_add_u32 s6, s6, 4096
    s_addc_u32 s7, s7, 0
    s_add_u32 m0, s21, 75776
    s_nop 0
    global_load_lds_dwordx4 v1, s[6:7]
    s_add_u32 s6, s6, 4096
    s_addc_u32 s7, s7, 0
    s_add_u32 m0, s26, 79872
    s_nop 0
    global_load_lds_dwordx4 v1, s[10:11]
    s_add_u32 s6, s6, 2048
    s_addc_u32 s7, s7, 0
    s_add_u32 s10, s10, 14336
    s_addc_u32 s11, s11, 0
    s_waitcnt vmcnt(34)
    s_barrier
    s_cmp_ge_u32 s47, 11
    s_cbranch_scc1 .ere_k3_kernel_41
    s_mov_b32 s39, 0
    v_mov_b32 v33, 163724
    s_cmp_lg_u32 s24, 0
    s_cbranch_scc1 .erl_k3_kernel_40
.er_k3_kernel_39:
    global_load_dword v32, v34, s[12:13] sc1
    s_waitcnt vmcnt(0)
    v_cmp_gt_u32 vcc, 4, v32
    s_nop 3
    s_or_b32 s38, vcc_lo, 0x10000
    s_ff1_i32_b32 s47, s38
    v_mov_b32 v32, s47
    ds_write_b32 v33, v32
    s_add_u32 s39, s39, 1
    s_cmp_ge_u32 s47, 11
    s_cbranch_scc1 .ere_k3_kernel_41
    s_cmp_ge_u32 s39, 200000
    s_cbranch_scc1 .ere_k3_kernel_41
    s_sleep 4
    s_branch .er_k3_kernel_39
.erl_k3_kernel_40:
    ds_read_b32 v32, v33
    s_waitcnt lgkmcnt(0)
    v_readfirstlane_b32 s47, v32
    s_add_u32 s39, s39, 1
    s_cmp_ge_u32 s47, 11
    s_cbranch_scc1 .ere_k3_kernel_41
    s_cmp_ge_u32 s39, 1600000
    s_cbranch_scc1 .ere_k3_kernel_41
    s_sleep 2
    s_branch .erl_k3_kernel_40
.ere_k3_kernel_41:
    s_add_u32 m0, s21, 104448
    s_nop 0
    global_load_lds_dwordx4 v1, s[4:5] sc1
    s_add_u32 s4, s4, 1024
    s_addc_u32 s5, s5, 0
    s_add_u32 m0, s21, 108544
    s_nop 0
    global_load_lds_dwordx4 v1, s[4:5] sc1
    s_add_u32 s4, s4, 1024
    s_addc_u32 s5, s5, 0
    s_add_u32 m0, s21, 90112
    s_nop 0
    global_load_lds_dwordx4 v1, s[6:7]
    s_add_u32 s6, s6, 4096
    s_addc_u32 s7, s7, 0
    s_add_u32 m0, s21, 94208
    s_nop 0
    global_load_lds_dwordx4 v1, s[6:7]
    s_add_u32 s6, s6, 4096
    s_addc_u32 s7, s7, 0
    s_add_u32 m0, s21, 98304
    s_nop 0
    global_load_lds_dwordx4 v1, s[6:7]
    s_add_u32 s6, s6, 4096
    s_addc_u32 s7, s7, 0
    s_add_u32 m0, s26, 102400
    s_nop 0
    global_load_lds_dwordx4 v1, s[10:11]
    s_add_u32 s6, s6, 2048
    s_addc_u32 s7, s7, 0
    s_add_u32 s10, s10, 14336
    s_addc_u32 s11, s11, 0
    s_waitcnt vmcnt(34)
    s_barrier
    s_cmp_ge_u32 s47, 12
    s_cbranch_scc1 .ere_k3_kernel_44
    s_mov_b32 s39, 0
    v_mov_b32 v33, 163724
    s_cmp_lg_u32 s24, 0
    s_cbranch_scc1 .erl_k3_kernel_43
.er_k3_kernel_42:
    global_load_dword v32, v34, s[12:13] sc1
    s_waitcnt vmcnt(0)
    v_cmp_gt_u32 vcc, 4, v32
    s_nop 3
    s_or_b32 s38, vcc_lo, 0x10000
    s_ff1_i32_b32 s47, s38
    v_mov_b32 v32, s47
    ds_write_b32 v33, v32
    s_add_u32 s39, s39, 1
    s_cmp_ge_u32 s47, 12
    s_cbranch_scc1 .ere_k3_kernel_44
    s_cmp_ge_u32 s39, 200000
    s_cbranch_scc1 .ere_k3_kernel_44
    s_sleep 4
    s_branch .er_k3_kernel_42
.erl_k3_kernel_43:
    ds_read_b32 v32, v33
    s_waitcnt lgkmcnt(0)
    v_readfirstlane_b32 s47, v32
    s_add_u32 s39, s39, 1
    s_cmp_ge_u32 s47, 12
    s_cbranch_scc1 .ere_k3_kernel_44
    s_cmp_ge_u32 s39, 1600000
    s_cbranch_scc1 .ere_k3_kernel_44
    s_sleep 2
    s_branch .erl_k3_kernel_43
.ere_k3_kernel_44:
    s_add_u32 m0, s21, 126976
    s_nop 0
    global_load_lds_dwordx4 v1, s[4:5] sc1
    s_add_u32 s4, s4, 1024
    s_addc_u32 s5, s5, 0
    s_add_u32 m0, s21, 131072
    s_nop 0
    global_load_lds_dwordx4 v1, s[4:5] sc1
    s_add_u32 s4, s4, 1024
    s_addc_u32 s5, s5, 0
    s_add_u32 m0, s21, 112640
    s_nop 0
    global_load_lds_dwordx4 v1, s[6:7]
    s_add_u32 s6, s6, 4096
    s_addc_u32 s7, s7, 0
    s_add_u32 m0, s21, 116736
    s_nop 0
    global_load_lds_dwordx4 v1, s[6:7]
    s_add_u32 s6, s6, 4096
    s_addc_u32 s7, s7, 0
    s_add_u32 m0, s21, 120832
    s_nop 0
    global_load_lds_dwordx4 v1, s[6:7]
    s_add_u32 s6, s6, 4096
    s_addc_u32 s7, s7, 0
    s_add_u32 m0, s26, 124928
    s_nop 0
    global_load_lds_dwordx4 v1, s[10:11]
    s_add_u32 s6, s6, 2048
    s_addc_u32 s7, s7, 0
    s_add_u32 s10, s10, 14336
    s_addc_u32 s11, s11, 0
    s_waitcnt vmcnt(18)
    v_add_f32 v16, v16, v17
    v_add_f32 v16, v16, v18
    v_add_f32 v16, v16, v19
    v_add_f32 v16, v16, v20
    v_add_f32 v16, v16, v21
    v_add_f32 v16, v16, v22
    v_add_f32 v16, v16, v23
    v_add_f32 v16, v16, v24
    v_add_f32 v16, v16, v25
    v_add_f32 v16, v16, v26
    v_add_f32 v16, v16, v27
    v_add_f32 v16, v16, v28
    v_add_f32 v16, v16, v29
    v_add_f32 v16, v16, v30
    v_add_f32 v16, v16, v31
    ds_write_b32 v15, v16
    s_waitcnt lgkmcnt(0)
    s_barrier
    s_cmp_ge_u32 s47, 13
    s_cbranch_scc1 .ere_k3_kernel_47
    s_mov_b32 s39, 0
    v_mov_b32 v33, 163724
    s_cmp_lg_u32 s24, 0
    s_cbranch_scc1 .erl_k3_kernel_46
.er_k3_kernel_45:
    global_load_dword v32, v34, s[12:13] sc1
    s_waitcnt vmcnt(0)
    v_cmp_gt_u32 vcc, 4, v32
    s_nop 3
    s_or_b32 s38, vcc_lo, 0x10000
    s_ff1_i32_b32 s47, s38
    v_mov_b32 v32, s47
    ds_write_b32 v33, v32
    s_add_u32 s39, s39, 1
    s_cmp_ge_u32 s47, 13
    s_cbranch_scc1 .ere_k3_kernel_47
    s_cmp_ge_u32 s39, 200000
    s_cbranch_scc1 .ere_k3_kernel_47
    s_sleep 4
    s_branch .er_k3_kernel_45
.erl_k3_kernel_46:
    ds_read_b32 v32, v33
    s_waitcnt lgkmcnt(0)
    v_readfirstlane_b32 s47, v32
    s_add_u32 s39, s39, 1
    s_cmp_ge_u32 s47, 13
    s_cbranch_scc1 .ere_k3_kernel_47
    s_cmp_ge_u32 s39, 1600000
    s_cbranch_scc1 .ere_k3_kernel_47
    s_sleep 2
    s_branch .erl_k3_kernel_46
.ere_k3_kernel_47:
    s_add_u32 m0, s21, 14336
    s_nop 0
    global_load_lds_dwordx4 v1, s[4:5] sc1
    s_add_u32 s4, s4, 1024
    s_addc_u32 s5, s5, 0
    s_add_u32 m0, s21, 18432
    s_nop 0
    global_load_lds_dwordx4 v1, s[4:5] sc1
    s_add_u32 s4, s4, 1024
    s_addc_u32 s5, s5, 0
    s_add_u32 m0, s21, 0
    s_nop 0
    global_load_lds_dwordx4 v1, s[6:7]
    s_add_u32 s6, s6, 4096
    s_addc_u32 s7, s7, 0
    s_add_u32 m0, s21, 4096
    s_nop 0
    global_load_lds_dwordx4 v1, s[6:7]
    s_add_u32 s6, s6, 4096
    s_addc_u32 s7, s7, 0
    s_add_u32 m0, s21, 8192
    s_nop 0
    global_load_lds_dwordx4 v1, s[6:7]
    s_add_u32 s6, s6, 4096
    s_addc_u32 s7, s7, 0
    s_add_u32 m0, s26, 12288
    s_nop 0
    global_load_lds_dwordx4 v1, s[10:11]
    s_add_u32 s6, s6, 2048
    s_addc_u32 s7, s7, 0
    s_add_u32 s10, s10, 14336
    s_addc_u32 s11, s11, 0
    s_waitcnt vmcnt(18)
    s_barrier
    s_cmp_ge_u32 s47, 14
    s_cbranch_scc1 .ere_k3_kernel_50
    s_mov_b32 s39, 0
    v_mov_b32 v33, 163724
    s_cmp_lg_u32 s24, 0
    s_cbranch_scc1 .erl_k3_kernel_49
.er_k3_kernel_48:
    global_load_dword v32, v34, s[12:13] sc1
    s_waitcnt vmcnt(0)
    v_cmp_gt_u32 vcc, 4, v32
    s_nop 3
    s_or_b32 s38, vcc_lo, 0x10000
    s_ff1_i32_b32 s47, s38
    v_mov_b32 v32, s47
    ds_write_b32 v33, v32
    s_add_u32 s39, s39, 1
    s_cmp_ge_u32 s47, 14
    s_cbranch_scc1 .ere_k3_kernel_50
    s_cmp_ge_u32 s39, 200000
    s_cbranch_scc1 .ere_k3_kernel_50
    s_sleep 4
    s_branch .er_k3_kernel_48
.erl_k3_kernel_49:
    ds_read_b32 v32, v33
    s_waitcnt lgkmcnt(0)
    v_readfirstlane_b32 s47, v32
    s_add_u32 s39, s39, 1
    s_cmp_ge_u32 s47, 14
    s_cbranch_scc1 .ere_k3_kernel_50
    s_cmp_ge_u32 s39, 1600000
    s_cbranch_scc1 .ere_k3_kernel_50
    s_sleep 2
    s_branch .erl_k3_kernel_49
.ere_k3_kernel_50:
    s_add_u32 m0, s21, 36864
    s_nop 0
    global_load_lds_dwordx4 v1, s[4:5] sc1
    s_add_u32 s4, s4, 1024
    s_addc_u32 s5, s5, 0
    s_add_u32 m0, s21, 40960
    s_nop 0
    global_load_lds_dwordx4 v1, s[4:5] sc1
    s_add_u32 s4, s4, 1024
    s_addc_u32 s5, s5, 0
    s_add_u32 m0, s21, 22528
    s_nop 0
    global_load_lds_dwordx4 v1, s[6:7]
    s_add_u32 s6, s6, 4096
    s_addc_u32 s7, s7, 0
    s_add_u32 m0, s21, 26624
    s_nop 0
    global_load_lds_dwordx4 v1, s[6:7]
    s_add_u32 s6, s6, 4096
    s_addc_u32 s7, s7, 0
    s_add_u32 m0, s21, 30720
    s_nop 0
    global_load_lds_dwordx4 v1, s[6:7]
    s_add_u32 s6, s6, 4096
    s_addc_u32 s7, s7, 0
    s_add_u32 m0, s26, 34816
    s_nop 0
    global_load_lds_dwordx4 v1, s[10:11]
    s_add_u32 s6, s6, 2048
    s_addc_u32 s7, s7, 0
    s_add_u32 s10, s10, 14336
    s_addc_u32 s11, s11, 0
    s_waitcnt vmcnt(18)
    s_barrier
    s_cmp_ge_u32 s47, 15
    s_cbranch_scc1 .ere_k3_kernel_53
    s_mov_b32 s39, 0
    v_mov_b32 v33, 163724
    s_cmp_lg_u32 s24, 0
    s_cbranch_scc1 .erl_k3_kernel_52
.er_k3_kernel_51:
    global_load_dword v32, v34, s[12:13] sc1
    s_waitcnt vmcnt(0)
    v_cmp_gt_u32 vcc, 4, v32
    s_nop 3
    s_or_b32 s38, vcc_lo, 0x10000
    s_ff1_i32_b32 s47, s38
    v_mov_b32 v32, s47
    ds_write_b32 v33, v32
    s_add_u32 s39, s39, 1
    s_cmp_ge_u32 s47, 15
    s_cbranch_scc1 .ere_k3_kernel_53
    s_cmp_ge_u32 s39, 200000
    s_cbranch_scc1 .ere_k3_kernel_53
    s_sleep 4
    s_branch .er_k3_kernel_51
.erl_k3_kernel_52:
    ds_read_b32 v32, v33
    s_waitcnt lgkmcnt(0)
    v_readfirstlane_b32 s47, v32
    s_add_u32 s39, s39, 1
    s_cmp_ge_u32 s47, 15
    s_cbranch_scc1 .ere_k3_kernel_53
    s_cmp_ge_u32 s39, 1600000
    s_cbranch_scc1 .ere_k3_kernel_53
    s_sleep 2
    s_branch .erl_k3_kernel_52
.ere_k3_kernel_53:
    s_add_u32 m0, s21, 59392
    s_nop 0
    global_load_lds_dwordx4 v1, s[4:5] sc1
    s_add_u32 s4, s4, 1024
    s_addc_u32 s5, s5, 0
    s_add_u32 m0, s21, 63488
    s_nop 0
    global_load_lds_dwordx4 v1, s[4:5] sc1
    s_add_u32 s4, s4, 1024
    s_addc_u32 s5, s5, 0
    s_add_u32 m0, s21, 45056
    s_nop 0
    global_load_lds_dwordx4 v1, s[6:7]
    s_add_u32 s6, s6, 4096
    s_addc_u32 s7, s7, 0
    s_add_u32 m0, s21, 49152
    s_nop 0
    global_load_lds_dwordx4 v1, s[6:7]
    s_add_u32 s6, s6, 4096
    s_addc_u32 s7, s7, 0
    s_add_u32 m0, s21, 53248
    s_nop 0
    global_load_lds_dwordx4 v1, s[6:7]
    s_add_u32 s6, s6, 4096
    s_addc_u32 s7, s7, 0
    s_add_u32 m0, s26, 57344
    s_nop 0
    global_load_lds_dwordx4 v1, s[10:11]
    s_add_u32 s6, s6, 2048
    s_addc_u32 s7, s7, 0
    s_add_u32 s10, s10, 14336
    s_addc_u32 s11, s11, 0
    s_waitcnt vmcnt(18)
    s_barrier
    s_cmp_ge_u32 s47, 16
    s_cbranch_scc1 .ere_k3_kernel_56
    s_mov_b32 s39, 0
    v_mov_b32 v33, 163724
    s_cmp_lg_u32 s24, 0
    s_cbranch_scc1 .erl_k3_kernel_55
.er_k3_kernel_54:
    global_load_dword v32, v34, s[12:13] sc1
    s_waitcnt vmcnt(0)
    v_cmp_gt_u32 vcc, 4, v32
    s_nop 3
    s_or_b32 s38, vcc_lo, 0x10000
    s_ff1_i32_b32 s47, s38
    v_mov_b32 v32, s47
    ds_write_b32 v33, v32
    s_add_u32 s39, s39, 1
    s_cmp_ge_u32 s47, 16
    s_cbranch_scc1 .ere_k3_kernel_56
    s_cmp_ge_u32 s39, 200000
    s_cbranch_scc1 .ere_k3_kernel_56
    s_sleep 4
    s_branch .er_k3_kernel_54
.erl_k3_kernel_55:
    ds_read_b32 v32, v33
    s_waitcnt lgkmcnt(0)
    v_readfirstlane_b32 s47, v32
    s_add_u32 s39, s39, 1
    s_cmp_ge_u32 s47, 16
    s_cbranch_scc1 .ere_k3_kernel_56
    s_cmp_ge_u32 s39, 1600000
    s_cbranch_scc1 .ere_k3_kernel_56
    s_sleep 2
    s_branch .erl_k3_kernel_55
.ere_k3_kernel_56:
    s_add_u32 m0, s21, 81920
    s_nop 0
    global_load_lds_dwordx4 v1, s[4:5] sc1
    s_add_u32 s4, s4, 1024
    s_addc_u32 s5, s5, 0
    s_add_u32 m0, s21, 86016
    s_nop 0
    global_load_lds_dwordx4 v1, s[4:5] sc1
    s_add_u32 s4, s4, 1024
    s_addc_u32 s5, s5, 0
    s_add_u32 m0, s21, 67584
    s_nop 0
    global_load_lds_dwordx4 v1, s[6:7]
    s_add_u32 s6, s6, 4096
    s_addc_u32 s7, s7, 0
    s_add_u32 m0, s21, 71680
    s_nop 0
    global_load_lds_dwordx4 v1, s[6:7]
    s_add_u32 s6, s6, 4096
    s_addc_u32 s7, s7, 0
    s_add_u32 m0, s21, 75776
    s_nop 0
    global_load_lds_dwordx4 v1, s[6:7]
    s_add_u32 s6, s6, 4096
    s_addc_u32 s7, s7, 0
    s_add_u32 m0, s26, 79872
    s_nop 0
    global_load_lds_dwordx4 v1, s[10:11]
    s_add_u32 s6, s6, 2048
    s_addc_u32 s7, s7, 0
    s_add_u32 s10, s10, 14336
    s_addc_u32 s11, s11, 0
    s_waitcnt vmcnt(18)
    s_barrier
    s_waitcnt vmcnt(12)
    s_barrier
    s_waitcnt vmcnt(6)
    s_barrier
    s_waitcnt vmcnt(0)
    s_barrier
    s_mul_i32 s20, s41, 229376
    s_add_u32 s20, s20, 8388608
    s_lshl_b32 s21, s24, 11
    s_add_u32 s20, s20, s21
    s_add_u32 s6, s12, s20
    s_addc_u32 s7, s13, 0
    s_lshl_b32 s19, s42, 1
    s_lshr_b32 s22, s24, 1
    s_add_u32 s19, s19, s22
    s_mul_i32 s19, s19, 114688
    s_and_b32 s22, s24, 1
    s_lshl_b32 s22, s22, 11
    s_add_u32 s19, s19, s22
    s_add_u32 s19, s19, 10485760
    s_add_u32 s4, s12, s19
    s_addc_u32 s5, s13, 0
    s_barrier
    s_add_u32 m0, s21, 0
    s_nop 0
    global_load_lds_dwordx4 v1, s[6:7]
    global_load_lds_dwordx4 v1, s[6:7] offset:1024
    s_add_u32 s6, s6, 8192
    s_addc_u32 s7, s7, 0
    s_add_u32 m0, s21, 8192
    s_nop 0
    global_load_lds_dwordx4 v1, s[6:7]
    global_load_lds_dwordx4 v1, s[6:7] offset:1024
    s_add_u32 s6, s6, 8192
    s_addc_u32 s7, s7, 0
    s_add_u32 m0, s21, 16384
    s_nop 0
    global_load_lds_dwordx4 v1, s[6:7]
    global_load_lds_dwordx4 v1, s[6:7] offset:1024
    s_add_u32 s6, s6, 8192
    s_addc_u32 s7, s7, 0
    s_add_u32 m0, s21, 24576
    s_nop 0
    global_load_lds_dwordx4 v1, s[6:7]
    global_load_lds_dwordx4 v1, s[6:7] offset:1024
    s_add_u32 s6, s6, 8192
    s_addc_u32 s7, s7, 0
    s_add_u32 m0, s21, 32768
    s_nop 0
    global_load_lds_dwordx4 v1, s[6:7]
    global_load_lds_dwordx4 v1, s[6:7] offset:1024
    s_add_u32 s6, s6, 8192
    s_addc_u32 s7, s7, 0
    s_add_u32 m0, s21, 40960
    s_nop 0
    global_load_lds_dwordx4 v1, s[6:7]
    global_load_lds_dwordx4 v1, s[6:7] offset:1024
    s_add_u32 s6, s6, 8192
    s_addc_u32 s7, s7, 0
    s_add_u32 m0, s21, 49152
    s_nop 0
    global_load_lds_dwordx4 v1, s[6:7]
    global_load_lds_dwordx4 v1, s[6:7] offset:1024
    s_add_u32 s6, s6, 8192
    s_addc_u32 s7, s7, 0
    s_add_u32 m0, s21, 57344
    s_nop 0
    global_load_lds_dwordx4 v1, s[6:7]
    global_load_lds_dwordx4 v1, s[6:7] offset:1024
    s_add_u32 s6, s6, 8192
    s_addc_u32 s7, s7, 0
    s_add_u32 m0, s21, 65536
    s_nop 0
    global_load_lds_dwordx4 v1, s[6:7]
    global_load_lds_dwordx4 v1, s[6:7] offset:1024
    s_add_u32 s6, s6, 8192
    s_addc_u32 s7, s7, 0
    s_add_u32 m0, s21, 73728
    s_nop 0
    global_load_lds_dwordx4 v1, s[6:7]
    global_load_lds_dwordx4 v1, s[6:7] offset:1024
    s_add_u32 s6, s6, 8192
    s_addc_u32 s7, s7, 0
    s_waitcnt vmcnt(0)
    s_lshr_b32 s43, s42, 1
    s_lshl_b32 s43, s43, 8
    s_add_u32 s43, s43, 18874368
    s_lshr_b32 s43, s42, 1
    s_lshl_b32 s43, s43, 12
    s_add_u32 s43, s43, 18907136
    v_and_b32 v34, 63, v0
    v_min_u32 v34, 15, v34
    v_lshlrev_b32 v34, 8, v34
    v_add_u32 v34, s43, v34
    v_mov_b32 v33, 163716
    s_mov_b32 s47, 0
    v_mov_b32 v43, 163712
    s_mov_b32 s39, 0
.own_k3_kernel_57:
    ds_read_b32 v42, v43
    s_waitcnt lgkmcnt(0)
    v_readfirstlane_b32 s38, v42
    s_add_u32 s39, s39, 1
    s_cmp_ge_u32 s38, 4
    s_cbranch_scc1 .ownd_k3_kernel_58
    s_cmp_ge_u32 s39, 1600000
    s_cbranch_scc1 .ownd_k3_kernel_58
    s_sleep 2
    s_branch .own_k3_kernel_57
.ownd_k3_kernel_58:
    s_cmp_ge_u32 s47, 1
    s_cbranch_scc1 .ere_k3_kernel_61
    s_mov_b32 s39, 0
    v_mov_b32 v33, 163716
    s_cmp_lg_u32 s24, 0
    s_cbranch_scc1 .erl_k3_kernel_60
.er_k3_kernel_59:
    global_load_dword v32, v34, s[12:13] sc1
    s_waitcnt vmcnt(0)
    v_cmp_gt_u32 vcc, 1, v32
    s_nop 3
    s_or_b32 s38, vcc_lo, 0x10000
    s_ff1_i32_b32 s47, s38
    v_mov_b32 v32, s47
    ds_write_b32 v33, v32
    s_add_u32 s39, s39, 1
    s_cmp_ge_u32 s47, 1
    s_cbranch_scc1 .ere_k3_kernel_61
    s_cmp_ge_u32 s39, 200000
    s_cbranch_scc1 .ere_k3_kernel_61
    s_sleep 2
    s_branch .er_k3_kernel_59
.erl_k3_kernel_60:
    ds_read_b32 v32, v33
    s_waitcnt lgkmcnt(0)
    v_readfirstlane_b32 s47, v32
    s_add_u32 s39, s39, 1
    s_cmp_ge_u32 s47, 1
    s_cbranch_scc1 .ere_k3_kernel_61
    s_cmp_ge_u32 s39, 1600000
    s_cbranch_scc1 .ere_k3_kernel_61
    s_sleep 2
    s_branch .erl_k3_kernel_60
.ere_k3_kernel_61:
    s_add_u32 m0, s21, 81920
    s_nop 0
    global_load_lds_dwordx4 v1, s[4:5] sc1
    global_load_lds_dwordx4 v1, s[4:5] offset:1024 sc1
    s_add_u32 s4, s4, 4096
    s_addc_u32 s5, s5, 0
    s_cmp_ge_u32 s47, 2
    s_cbranch_scc1 .ere_k3_kernel_64
    s_mov_b32 s39, 0
    v_mov_b32 v33, 163716
    s_cmp_lg_u32 s24, 0
    s_cbranch_scc1 .erl_k3_kernel_63
.er_k3_kernel_62:
    global_load_dword v32, v34, s[12:13] sc1
    s_waitcnt vmcnt(0)
    v_cmp_gt_u32 vcc, 1, v32
    s_nop 3
    s_or_b32 s38, vcc_lo, 0x10000
    s_ff1_i32_b32 s47, s38
    v_mov_b32 v32, s47
    ds_write_b32 v33, v32
    s_add_u32 s39, s39, 1
    s_cmp_ge_u32 s47, 2
    s_cbranch_scc1 .ere_k3_kernel_64
    s_cmp_ge_u32 s39, 200000
    s_cbranch_scc1 .ere_k3_kernel_64
    s_sleep 2
    s_branch .er_k3_kernel_62
.erl_k3_kernel_63:
    ds_read_b32 v32, v33
    s_waitcnt lgkmcnt(0)
    v_readfirstlane_b32 s47, v32
    s_add_u32 s39, s39, 1
    s_cmp_ge_u32 s47, 2
    s_cbranch_scc1 .ere_k3_kernel_64
    s_cmp_ge_u32 s39, 1600000
    s_cbranch_scc1 .ere_k3_kernel_64
    s_sleep 2
    s_branch .erl_k3_kernel_63
.ere_k3_kernel_64:
    s_add_u32 m0, s21, 90112
    s_nop 0
    global_load_lds_dwordx4 v1, s[4:5] sc1
    global_load_lds_dwordx4 v1, s[4:5] offset:1024 sc1
    s_add_u32 s4, s4, 4096
    s_addc_u32 s5, s5, 0
    s_cmp_ge_u32 s47, 2
    s_cbranch_scc1 .ere_k3_kernel_67
    s_mov_b32 s39, 0
    v_mov_b32 v33, 163716
    s_cmp_lg_u32 s24, 0
    s_cbranch_scc1 .erl_k3_kernel_66
.er_k3_kernel_65:
    global_load_dword v32, v34, s[12:13] sc1
    s_waitcnt vmcnt(0)
    v_cmp_gt_u32 vcc, 1, v32
    s_nop 3
    s_or_b32 s38, vcc_lo, 0x10000
    s_ff1_i32_b32 s47, s38
    v_mov_b32 v32, s47
    ds_write_b32 v33, v32
    s_add_u32 s39, s39, 1
    s_cmp_ge_u32 s47, 2
    s_cbranch_scc1 .ere_k3_kernel_67
    s_cmp_ge_u32 s39, 200000
    s_cbranch_scc1 .ere_k3_kernel_67
    s_sleep 2
    s_branch .er_k3_kernel_65
.erl_k3_kernel_66:
    ds_read_b32 v32, v33
    s_waitcnt lgkmcnt(0)
    v_readfirstlane_b32 s47, v32
    s_add_u32 s39, s39, 1
    s_cmp_ge_u32 s47, 2
    s_cbranch_scc1 .ere_k3_kernel_67
    s_cmp_ge_u32 s39, 1600000
    s_cbranch_scc1 .ere_k3_kernel_67
    s_sleep 2
    s_branch .erl_k3_kernel_66
.ere_k3_kernel_67:
    s_add_u32 m0, s21, 98304
    s_nop 0
    global_load_lds_dwordx4 v1, s[4:5] sc1
    global_load_lds_dwordx4 v1, s[4:5] offset:1024 sc1
    s_add_u32 s4, s4, 4096
    s_addc_u32 s5, s5, 0
    s_cmp_ge_u32 s47, 3
    s_cbranch_scc1 .ere_k3_kernel_70
    s_mov_b32 s39, 0
    v_mov_b32 v33, 163716
    s_cmp_lg_u32 s24, 0
    s_cbranch_scc1 .erl_k3_kernel_69
.er_k3_kernel_68:
    global_load_dword v32, v34, s[12:13] sc1
    s_waitcnt vmcnt(0)
    v_cmp_gt_u32 vcc, 1, v32
    s_nop 3
    s_or_b32 s38, vcc_lo, 0x10000
    s_ff1_i32_b32 s47, s38
    v_mov_b32 v32, s47
    ds_write_b32 v33, v32
    s_add_u32 s39, s39, 1
    s_cmp_ge_u32 s47, 3
    s_cbranch_scc1 .ere_k3_kernel_70
    s_cmp_ge_u32 s39, 200000
    s_cbranch_scc1 .ere_k3_kernel_70
    s_sleep 2
    s_branch .er_k3_kernel_68
.erl_k3_kernel_69:
    ds_read_b32 v32, v33
    s_waitcnt lgkmcnt(0)
    v_readfirstlane_b32 s47, v32
    s_add_u32 s39, s39, 1
    s_cmp_ge_u32 s47, 3
    s_cbranch_scc1 .ere_k3_kernel_70
    s_cmp_ge_u32 s39, 1600000
    s_cbranch_scc1 .ere_k3_kernel_70
    s_sleep 2
    s_branch .erl_k3_kernel_69
.ere_k3_kernel_70:
    s_add_u32 m0, s21, 106496
    s_nop 0
    global_load_lds_dwordx4 v1, s[4:5] sc1
    global_load_lds_dwordx4 v1, s[4:5] offset:1024 sc1
    s_add_u32 s4, s4, 4096
    s_addc_u32 s5, s5, 0
    s_cmp_ge_u32 s47, 3
    s_cbranch_scc1 .ere_k3_kernel_73
    s_mov_b32 s39, 0
    v_mov_b32 v33, 163716
    s_cmp_lg_u32 s24, 0
    s_cbranch_scc1 .erl_k3_kernel_72
.er_k3_kernel_71:
    global_load_dword v32, v34, s[12:13] sc1
    s_waitcnt vmcnt(0)
    v_cmp_gt_u32 vcc, 1, v32
    s_nop 3
    s_or_b32 s38, vcc_lo, 0x10000
    s_ff1_i32_b32 s47, s38
    v_mov_b32 v32, s47
    ds_write_b32 v33, v32
    s_add_u32 s39, s39, 1
    s_cmp_ge_u32 s47, 3
    s_cbranch_scc1 .ere_k3_kernel_73
    s_cmp_ge_u32 s39, 200000
    s_cbranch_scc1 .ere_k3_kernel_73
    s_sleep 2
    s_branch .er_k3_kernel_71
.erl_k3_kernel_72:
    ds_read_b32 v32, v33
    s_waitcnt lgkmcnt(0)
    v_readfirstlane_b32 s47, v32
    s_add_u32 s39, s39, 1
    s_cmp_ge_u32 s47, 3
    s_cbranch_scc1 .ere_k3_kernel_73
    s_cmp_ge_u32 s39, 1600000
    s_cbranch_scc1 .ere_k3_kernel_73
    s_sleep 2
    s_branch .erl_k3_kernel_72
.ere_k3_kernel_73:
    s_add_u32 m0, s21, 114688
    s_nop 0
    global_load_lds_dwordx4 v1, s[4:5] sc1
    global_load_lds_dwordx4 v1, s[4:5] offset:1024 sc1
    s_add_u32 s4, s4, 4096
    s_addc_u32 s5, s5, 0
    s_cmp_ge_u32 s47, 4
    s_cbranch_scc1 .ere_k3_kernel_76
    s_mov_b32 s39, 0
    v_mov_b32 v33, 163716
    s_cmp_lg_u32 s24, 0
    s_cbranch_scc1 .erl_k3_kernel_75
.er_k3_kernel_74:
    global_load_dword v32, v34, s[12:13] sc1
    s_waitcnt vmcnt(0)
    v_cmp_gt_u32 vcc, 1, v32
    s_nop 3
    s_or_b32 s38, vcc_lo, 0x10000
    s_ff1_i32_b32 s47, s38
    v_mov_b32 v32, s47
    ds_write_b32 v33, v32
    s_add_u32 s39, s39, 1
    s_cmp_ge_u32 s47, 4
    s_cbranch_scc1 .ere_k3_kernel_76
    s_cmp_ge_u32 s39, 200000
    s_cbranch_scc1 .ere_k3_kernel_76
    s_sleep 2
    s_branch .er_k3_kernel_74
.erl_k3_kernel_75:
    ds_read_b32 v32, v33
    s_waitcnt lgkmcnt(0)
    v_readfirstlane_b32 s47, v32
    s_add_u32 s39, s39, 1
    s_cmp_ge_u32 s47, 4
    s_cbranch_scc1 .ere_k3_kernel_76
    s_cmp_ge_u32 s39, 1600000
    s_cbranch_scc1 .ere_k3_kernel_76
    s_sleep 2
    s_branch .erl_k3_kernel_75
.ere_k3_kernel_76:
    s_add_u32 m0, s21, 122880
    s_nop 0
    global_load_lds_dwordx4 v1, s[4:5] sc1
    global_load_lds_dwordx4 v1, s[4:5] offset:1024 sc1
    s_add_u32 s4, s4, 4096
    s_addc_u32 s5, s5, 0
    s_waitcnt vmcnt(10)
    s_barrier
    s_waitcnt vmcnt(8)
    s_barrier
    s_waitcnt vmcnt(6)
    s_barrier
    s_cmp_ge_u32 s47, 4
    s_cbranch_scc1 .ere_k3_kernel_79
    s_mov_b32 s39, 0
    v_mov_b32 v33, 163716
    s_cmp_lg_u32 s24, 0
    s_cbranch_scc1 .erl_k3_kernel_78
.er_k3_kernel_77:
    global_load_dword v32, v34, s[12:13] sc1
    s_waitcnt vmcnt(0)
    v_cmp_gt_u32 vcc, 1, v32
    s_nop 3
    s_or_b32 s38, vcc_lo, 0x10000
    s_ff1_i32_b32 s47, s38
    v_mov_b32 v32, s47
    ds_write_b32 v33, v32
    s_add_u32 s39, s39, 1
    s_cmp_ge_u32 s47, 4
    s_cbranch_scc1 .ere_k3_kernel_79
    s_cmp_ge_u32 s39, 200000
    s_cbranch_scc1 .ere_k3_kernel_79
    s_sleep 2
    s_branch .er_k3_kernel_77
.erl_k3_kernel_78:
    ds_read_b32 v32, v33
    s_waitcnt lgkmcnt(0)
    v_readfirstlane_b32 s47, v32
    s_add_u32 s39, s39, 1
    s_cmp_ge_u32 s47, 4
    s_cbranch_scc1 .ere_k3_kernel_79
    s_cmp_ge_u32 s39, 1600000
    s_cbranch_scc1 .ere_k3_kernel_79
    s_sleep 2
    s_branch .erl_k3_kernel_78
.ere_k3_kernel_79:
    s_add_u32 m0, s21, 81920
    s_nop 0
    global_load_lds_dwordx4 v1, s[4:5] sc1
    global_load_lds_dwordx4 v1, s[4:5] offset:1024 sc1
    s_add_u32 s4, s4, 4096
    s_addc_u32 s5, s5, 0
    s_add_u32 m0, s21, 0
    s_nop 0
    global_load_lds_dwordx4 v1, s[6:7]
    global_load_lds_dwordx4 v1, s[6:7] offset:1024
    s_add_u32 s6, s6, 8192
    s_addc_u32 s7, s7, 0
    s_waitcnt vmcnt(8)
    s_barrier
    s_cmp_ge_u32 s47, 5
    s_cbranch_scc1 .ere_k3_kernel_82
    s_mov_b32 s39, 0
    v_mov_b32 v33, 163716
    s_cmp_lg_u32 s24, 0
    s_cbranch_scc1 .erl_k3_kernel_81
.er_k3_kernel_80:
    global_load_dword v32, v34, s[12:13] sc1
    s_waitcnt vmcnt(0)
    v_cmp_gt_u32 vcc, 1, v32
    s_nop 3
    s_or_b32 s38, vcc_lo, 0x10000
    s_ff1_i32_b32 s47, s38
    v_mov_b32 v32, s47
    ds_write_b32 v33, v32
    s_add_u32 s39, s39, 1
    s_cmp_ge_u32 s47, 5
    s_cbranch_scc1 .ere_k3_kernel_82
    s_cmp_ge_u32 s39, 200000
    s_cbranch_scc1 .ere_k3_kernel_82
    s_sleep 2
    s_branch .er_k3_kernel_80
.erl_k3_kernel_81:
    ds_read_b32 v32, v33
    s_waitcnt lgkmcnt(0)
    v_readfirstlane_b32 s47, v32
    s_add_u32 s39, s39, 1
    s_cmp_ge_u32 s47, 5
    s_cbranch_scc1 .ere_k3_kernel_82
    s_cmp_ge_u32 s39, 1600000
    s_cbranch_scc1 .ere_k3_kernel_82
    s_sleep 2
    s_branch .erl_k3_kernel_81
.ere_k3_kernel_82:
    s_add_u32 m0, s21, 90112
    s_nop 0
    global_load_lds_dwordx4 v1, s[4:5] sc1
    global_load_lds_dwordx4 v1, s[4:5] offset:1024 sc1
    s_add_u32 s4, s4, 4096
    s_addc_u32 s5, s5, 0
    s_add_u32 m0, s21, 8192
    s_nop 0
    global_load_lds_dwordx4 v1, s[6:7]
    global_load_lds_dwordx4 v1, s[6:7] offset:1024
    s_add_u32 s6, s6, 8192
    s_addc_u32 s7, s7, 0
    s_waitcnt vmcnt(10)
    s_barrier
    s_cmp_ge_u32 s47, 6
    s_cbranch_scc1 .ere_k3_kernel_85
    s_mov_b32 s39, 0
    v_mov_b32 v33, 163716
    s_cmp_lg_u32 s24, 0
    s_cbranch_scc1 .erl_k3_kernel_84
.er_k3_kernel_83:
    global_load_dword v32, v34, s[12:13] sc1
    s_waitcnt vmcnt(0)
    v_cmp_gt_u32 vcc, 1, v32
    s_nop 3
    s_or_b32 s38, vcc_lo, 0x10000
    s_ff1_i32_b32 s47, s38
    v_mov_b32 v32, s47
    ds_write_b32 v33, v32
    s_add_u32 s39, s39, 1
    s_cmp_ge_u32 s47, 6
    s_cbranch_scc1 .ere_k3_kernel_85
    s_cmp_ge_u32 s39, 200000
    s_cbranch_scc1 .ere_k3_kernel_85
    s_sleep 2
    s_branch .er_k3_kernel_83
.erl_k3_kernel_84:
    ds_read_b32 v32, v33
    s_waitcnt lgkmcnt(0)
    v_readfirstlane_b32 s47, v32
    s_add_u32 s39, s39, 1
    s_cmp_ge_u32 s47, 6
    s_cbranch_scc1 .ere_k3_kernel_85
    s_cmp_ge_u32 s39, 1600000
    s_cbranch_scc1 .ere_k3_kernel_85
    s_sleep 2
    s_branch .erl_k3_kernel_84
.ere_k3_kernel_85:
    s_add_u32 m0, s21, 98304
    s_nop 0
    global_load_lds_dwordx4 v1, s[4:5] sc1
    global_load_lds_dwordx4 v1, s[4:5] offset:1024 sc1
    s_add_u32 s4, s4, 4096
    s_addc_u32 s5, s5, 0
    s_add_u32 m0, s21, 16384
    s_nop 0
    global_load_lds_dwordx4 v1, s[6:7]
    global_load_lds_dwordx4 v1, s[6:7] offset:1024
    s_add_u32 s6, s6, 8192
    s_addc_u32 s7, s7, 0
    s_waitcnt vmcnt(12)
    s_barrier
    s_cmp_ge_u32 s47, 6
    s_cbranch_scc1 .ere_k3_kernel_88
    s_mov_b32 s39, 0
    v_mov_b32 v33, 163716
    s_cmp_lg_u32 s24, 0
    s_cbranch_scc1 .erl_k3_kernel_87
.er_k3_kernel_86:
    global_load_dword v32, v34, s[12:13] sc1
    s_waitcnt vmcnt(0)
    v_cmp_gt_u32 vcc, 1, v32
    s_nop 3
    s_or_b32 s38, vcc_lo, 0x10000
    s_ff1_i32_b32 s47, s38
    v_mov_b32 v32, s47
    ds_write_b32 v33, v32
    s_add_u32 s39, s39, 1
    s_cmp_ge_u32 s47, 6
    s_cbranch_scc1 .ere_k3_kernel_88
    s_cmp_ge_u32 s39, 200000
    s_cbranch_scc1 .ere_k3_kernel_88
    s_sleep 2
    s_branch .er_k3_kernel_86
.erl_k3_kernel_87:
    ds_read_b32 v32, v33
    s_waitcnt lgkmcnt(0)
    v_readfirstlane_b32 s47, v32
    s_add_u32 s39, s39, 1
    s_cmp_ge_u32 s47, 6
    s_cbranch_scc1 .ere_k3_kernel_88
    s_cmp_ge_u32 s39, 1600000
    s_cbranch_scc1 .ere_k3_kernel_88
    s_sleep 2
    s_branch .erl_k3_kernel_87
.ere_k3_kernel_88:
    s_add_u32 m0, s21, 106496
    s_nop 0
    global_load_lds_dwordx4 v1, s[4:5] sc1
    global_load_lds_dwordx4 v1, s[4:5] offset:1024 sc1
    s_add_u32 s4, s4, 4096
    s_addc_u32 s5, s5, 0
    s_add_u32 m0, s21, 24576
    s_nop 0
    global_load_lds_dwordx4 v1, s[6:7]
    global_load_lds_dwordx4 v1, s[6:7] offset:1024
    s_add_u32 s6, s6, 8192
    s_addc_u32 s7, s7, 0
    s_waitcnt vmcnt(14)
    s_barrier
    s_cmp_ge_u32 s47, 7
    s_cbranch_scc1 .ere_k3_kernel_91
    s_mov_b32 s39, 0
    v_mov_b32 v33, 163716
    s_cmp_lg_u32 s24, 0
    s_cbranch_scc1 .erl_k3_kernel_90
.er_k3_kernel_89:
    global_load_dword v32, v34, s[12:13] sc1
    s_waitcnt vmcnt(0)
    v_cmp_gt_u32 vcc, 1, v32
    s_nop 3
    s_or_b32 s38, vcc_lo, 0x10000
    s_ff1_i32_b32 s47, s38
    v_mov_b32 v32, s47
    ds_write_b32 v33, v32
    s_add_u32 s39, s39, 1
    s_cmp_ge_u32 s47, 7
    s_cbranch_scc1 .ere_k3_kernel_91
    s_cmp_ge_u32 s39, 200000
    s_cbranch_scc1 .ere_k3_kernel_91
    s_sleep 2
    s_branch .er_k3_kernel_89
.erl_k3_kernel_90:
    ds_read_b32 v32, v33
    s_waitcnt lgkmcnt(0)
    v_readfirstlane_b32 s47, v32
    s_add_u32 s39, s39, 1
    s_cmp_ge_u32 s47, 7
    s_cbranch_scc1 .ere_k3_kernel_91
    s_cmp_ge_u32 s39, 1600000
    s_cbranch_scc1 .ere_k3_kernel_91
    s_sleep 2
    s_branch .erl_k3_kernel_90
.ere_k3_kernel_91:
    s_add_u32 m0, s21, 114688
    s_nop 0
    global_load_lds_dwordx4 v1, s[4:5] sc1
    global_load_lds_dwordx4 v1, s[4:5] offset:1024 sc1
    s_add_u32 s4, s4, 4096
    s_addc_u32 s5, s5, 0
    s_add_u32 m0, s21, 32768
    s_nop 0
    global_load_lds_dwordx4 v1, s[6:7]
    global_load_lds_dwordx4 v1, s[6:7] offset:1024
    s_add_u32 s6, s6, 8192
    s_addc_u32 s7, s7, 0
    s_waitcnt vmcnt(14)
    s_barrier
    s_cmp_ge_u32 s47, 7
    s_cbranch_scc1 .ere_k3_kernel_94
    s_mov_b32 s39, 0
    v_mov_b32 v33, 163716
    s_cmp_lg_u32 s24, 0
    s_cbranch_scc1 .erl_k3_kernel_93
.er_k3_kernel_92:
    global_load_dword v32, v34, s[12:13] sc1
    s_waitcnt vmcnt(0)
    v_cmp_gt_u32 vcc, 1, v32
    s_nop 3
    s_or_b32 s38, vcc_lo, 0x10000
    s_ff1_i32_b32 s47, s38
    v_mov_b32 v32, s47
    ds_write_b32 v33, v32
    s_add_u32 s39, s39, 1
    s_cmp_ge_u32 s47, 7
    s_cbranch_scc1 .ere_k3_kernel_94
    s_cmp_ge_u32 s39, 200000
    s_cbranch_scc1 .ere_k3_kernel_94
    s_sleep 2
    s_branch .er_k3_kernel_92
.erl_k3_kernel_93:
    ds_read_b32 v32, v33
    s_waitcnt lgkmcnt(0)
    v_readfirstlane_b32 s47, v32
    s_add_u32 s39, s39, 1
    s_cmp_ge_u32 s47, 7
    s_cbranch_scc1 .ere_k3_kernel_94
    s_cmp_ge_u32 s39, 1600000
    s_cbranch_scc1 .ere_k3_kernel_94
    s_sleep 2
    s_branch .erl_k3_kernel_93
.ere_k3_kernel_94:
    s_add_u32 m0, s21, 122880
    s_nop 0
    global_load_lds_dwordx4 v1, s[4:5] sc1
    global_load_lds_dwordx4 v1, s[4:5] offset:1024 sc1
    s_add_u32 s4, s4, 4096
    s_addc_u32 s5, s5, 0
    s_add_u32 m0, s21, 40960
    s_nop 0
    global_load_lds_dwordx4 v1, s[6:7]
    global_load_lds_dwordx4 v1, s[6:7] offset:1024
    s_add_u32 s6, s6, 8192
    s_addc_u32 s7, s7, 0
    s_waitcnt vmcnt(14)
    s_barrier
    s_cmp_ge_u32 s47, 8
    s_cbranch_scc1 .ere_k3_kernel_97
    s_mov_b32 s39, 0
    v_mov_b32 v33, 163716
    s_cmp_lg_u32 s24, 0
    s_cbranch_scc1 .erl_k3_kernel_96
.er_k3_kernel_95:
    global_load_dword v32, v34, s[12:13] sc1
    s_waitcnt vmcnt(0)
    v_cmp_gt_u32 vcc, 1, v32
    s_nop 3
    s_or_b32 s38, vcc_lo, 0x10000
    s_ff1_i32_b32 s47, s38
    v_mov_b32 v32, s47
    ds_write_b32 v33, v32
    s_add_u32 s39, s39, 1
    s_cmp_ge_u32 s47, 8
    s_cbranch_scc1 .ere_k3_kernel_97
    s_cmp_ge_u32 s39, 200000
    s_cbranch_scc1 .ere_k3_kernel_97
    s_sleep 2
    s_branch .er_k3_kernel_95
.erl_k3_kernel_96:
    ds_read_b32 v32, v33
    s_waitcnt lgkmcnt(0)
    v_readfirstlane_b32 s47, v32
    s_add_u32 s39, s39, 1
    s_cmp_ge_u32 s47, 8
    s_cbranch_scc1 .ere_k3_kernel_97
    s_cmp_ge_u32 s39, 1600000
    s_cbranch_scc1 .ere_k3_kernel_97
    s_sleep 2
    s_branch .erl_k3_kernel_96
.ere_k3_kernel_97:
    s_add_u32 m0, s21, 81920
    s_nop 0
    global_load_lds_dwordx4 v1, s[4:5] sc1
    global_load_lds_dwordx4 v1, s[4:5] offset:1024 sc1
    s_add_u32 s4, s4, 4096
    s_addc_u32 s5, s5, 0
    s_add_u32 m0, s21, 49152
    s_nop 0
    global_load_lds_dwordx4 v1, s[6:7]
    global_load_lds_dwordx4 v1, s[6:7] offset:1024
    s_add_u32 s6, s6, 8192
    s_addc_u32 s7, s7, 0
    s_waitcnt vmcnt(14)
    s_barrier
    s_cmp_ge_u32 s47, 8
    s_cbranch_scc1 .ere_k3_kernel_100
    s_mov_b32 s39, 0
    v_mov_b32 v33, 163716
    s_cmp_lg_u32 s24, 0
    s_cbranch_scc1 .erl_k3_kernel_99
.er_k3_kernel_98:
    global_load_dword v32, v34, s[12:13] sc1
    s_waitcnt vmcnt(0)
    v_cmp_gt_u32 vcc, 1, v32
    s_nop 3
    s_or_b32 s38, vcc_lo, 0x10000
    s_ff1_i32_b32 s47, s38
    v_mov_b32 v32, s47
    ds_write_b32 v33, v32
    s_add_u32 s39, s39, 1
    s_cmp_ge_u32 s47, 8
    s_cbranch_scc1 .ere_k3_kernel_100
    s_cmp_ge_u32 s39, 200000
    s_cbranch_scc1 .ere_k3_kernel_100
    s_sleep 2
    s_branch .er_k3_kernel_98
.erl_k3_kernel_99:
    ds_read_b32 v32, v33
    s_waitcnt lgkmcnt(0)
    v_readfirstlane_b32 s47, v32
    s_add_u32 s39, s39, 1
    s_cmp_ge_u32 s47, 8
    s_cbranch_scc1 .ere_k3_kernel_100
    s_cmp_ge_u32 s39, 1600000
    s_cbranch_scc1 .ere_k3_kernel_100
    s_sleep 2
    s_branch .erl_k3_kernel_99
.ere_k3_kernel_100:
    s_add_u32 m0, s21, 90112
    s_nop 0
    global_load_lds_dwordx4 v1, s[4:5] sc1
    global_load_lds_dwordx4 v1, s[4:5] offset:1024 sc1
    s_add_u32 s4, s4, 4096
    s_addc_u32 s5, s5, 0
    s_add_u32 m0, s21, 57344
    s_nop 0
    global_load_lds_dwordx4 v1, s[6:7]
    global_load_lds_dwordx4 v1, s[6:7] offset:1024
    s_add_u32 s6, s6, 8192
    s_addc_u32 s7, s7, 0
    s_waitcnt vmcnt(14)
    s_barrier
    s_cmp_ge_u32 s47, 9
    s_cbranch_scc1 .ere_k3_kernel_103
    s_mov_b32 s39, 0
    v_mov_b32 v33, 163716
    s_cmp_lg_u32 s24, 0
    s_cbranch_scc1 .erl_k3_kernel_102
.er_k3_kernel_101:
    global_load_dword v32, v34, s[12:13] sc1
    s_waitcnt vmcnt(0)
    v_cmp_gt_u32 vcc, 1, v32
    s_nop 3
    s_or_b32 s38, vcc_lo, 0x10000
    s_ff1_i32_b32 s47, s38
    v_mov_b32 v32, s47
    ds_write_b32 v33, v32
    s_add_u32 s39, s39, 1
    s_cmp_ge_u32 s47, 9
    s_cbranch_scc1 .ere_k3_kernel_103
    s_cmp_ge_u32 s39, 200000
    s_cbranch_scc1 .ere_k3_kernel_103
    s_sleep 2
    s_branch .er_k3_kernel_101
.erl_k3_kernel_102:
    ds_read_b32 v32, v33
    s_waitcnt lgkmcnt(0)
    v_readfirstlane_b32 s47, v32
    s_add_u32 s39, s39, 1
    s_cmp_ge_u32 s47, 9
    s_cbranch_scc1 .ere_k3_kernel_103
    s_cmp_ge_u32 s39, 1600000
    s_cbranch_scc1 .ere_k3_kernel_103
    s_sleep 2
    s_branch .erl_k3_kernel_102
.ere_k3_kernel_103:
    s_add_u32 m0, s21, 98304
    s_nop 0
    global_load_lds_dwordx4 v1, s[4:5] sc1
    global_load_lds_dwordx4 v1, s[4:5] offset:1024 sc1
    s_add_u32 s4, s4, 4096
    s_addc_u32 s5, s5, 0
    s_add_u32 m0, s21, 65536
    s_nop 0
    global_load_lds_dwordx4 v1, s[6:7]
    global_load_lds_dwordx4 v1, s[6:7] offset:1024
    s_add_u32 s6, s6, 8192
    s_addc_u32 s7, s7, 0
    s_waitcnt vmcnt(14)
    s_barrier
    s_cmp_ge_u32 s47, 10
    s_cbranch_scc1 .ere_k3_kernel_106
    s_mov_b32 s39, 0
    v_mov_b32 v33, 163716
    s_cmp_lg_u32 s24, 0
    s_cbranch_scc1 .erl_k3_kernel_105
.er_k3_kernel_104:
    global_load_dword v32, v34, s[12:13] sc1
    s_waitcnt vmcnt(0)
    v_cmp_gt_u32 vcc, 1, v32
    s_nop 3
    s_or_b32 s38, vcc_lo, 0x10000
    s_ff1_i32_b32 s47, s38
    v_mov_b32 v32, s47
    ds_write_b32 v33, v32
    s_add_u32 s39, s39, 1
    s_cmp_ge_u32 s47, 10
    s_cbranch_scc1 .ere_k3_kernel_106
    s_cmp_ge_u32 s39, 200000
    s_cbranch_scc1 .ere_k3_kernel_106
    s_sleep 2
    s_branch .er_k3_kernel_104
.erl_k3_kernel_105:
    ds_read_b32 v32, v33
    s_waitcnt lgkmcnt(0)
    v_readfirstlane_b32 s47, v32
    s_add_u32 s39, s39, 1
    s_cmp_ge_u32 s47, 10
    s_cbranch_scc1 .ere_k3_kernel_106
    s_cmp_ge_u32 s39, 1600000
    s_cbranch_scc1 .ere_k3_kernel_106
    s_sleep 2
    s_branch .erl_k3_kernel_105
.ere_k3_kernel_106:
    s_add_u32 m0, s21, 106496
    s_nop 0
    global_load_lds_dwordx4 v1, s[4:5] sc1
    global_load_lds_dwordx4 v1, s[4:5] offset:1024 sc1
    s_add_u32 s4, s4, 4096
    s_addc_u32 s5, s5, 0
    s_add_u32 m0, s21, 73728
    s_nop 0
    global_load_lds_dwordx4 v1, s[6:7]
    global_load_lds_dwordx4 v1, s[6:7] offset:1024
    s_add_u32 s6, s6, 8192
    s_addc_u32 s7, s7, 0
    s_waitcnt vmcnt(14)
    s_barrier
    s_cmp_ge_u32 s47, 10
    s_cbranch_scc1 .ere_k3_kernel_109
    s_mov_b32 s39, 0
    v_mov_b32 v33, 163716
    s_cmp_lg_u32 s24, 0
    s_cbranch_scc1 .erl_k3_kernel_108
.er_k3_kernel_107:
    global_load_dword v32, v34, s[12:13] sc1
    s_waitcnt vmcnt(0)
    v_cmp_gt_u32 vcc, 1, v32
    s_nop 3
    s_or_b32 s38, vcc_lo, 0x10000
    s_ff1_i32_b32 s47, s38
    v_mov_b32 v32, s47
    ds_write_b32 v33, v32
    s_add_u32 s39, s39, 1
    s_cmp_ge_u32 s47, 10
    s_cbranch_scc1 .ere_k3_kernel_109
    s_cmp_ge_u32 s39, 200000
    s_cbranch_scc1 .ere_k3_kernel_109
    s_sleep 2
    s_branch .er_k3_kernel_107
.erl_k3_kernel_108:
    ds_read_b32 v32, v33
    s_waitcnt lgkmcnt(0)
    v_readfirstlane_b32 s47, v32
    s_add_u32 s39, s39, 1
    s_cmp_ge_u32 s47, 10
    s_cbranch_scc1 .ere_k3_kernel_109
    s_cmp_ge_u32 s39, 1600000
    s_cbranch_scc1 .ere_k3_kernel_109
    s_sleep 2
    s_branch .erl_k3_kernel_108
.ere_k3_kernel_109:
    s_add_u32 m0, s21, 114688
    s_nop 0
    global_load_lds_dwordx4 v1, s[4:5] sc1
    global_load_lds_dwordx4 v1, s[4:5] offset:1024 sc1
    s_add_u32 s4, s4, 4096
    s_addc_u32 s5, s5, 0
    s_add_u32 m0, s21, 0
    s_nop 0
    global_load_lds_dwordx4 v1, s[6:7]
    global_load_lds_dwordx4 v1, s[6:7] offset:1024
    s_add_u32 s6, s6, 8192
    s_addc_u32 s7, s7, 0
    s_waitcnt vmcnt(14)
    s_barrier
    s_cmp_ge_u32 s47, 11
    s_cbranch_scc1 .ere_k3_kernel_112
    s_mov_b32 s39, 0
    v_mov_b32 v33, 163716
    s_cmp_lg_u32 s24, 0
    s_cbranch_scc1 .erl_k3_kernel_111
.er_k3_kernel_110:
    global_load_dword v32, v34, s[12:13] sc1
    s_waitcnt vmcnt(0)
    v_cmp_gt_u32 vcc, 1, v32
    s_nop 3
    s_or_b32 s38, vcc_lo, 0x10000
    s_ff1_i32_b32 s47, s38
    v_mov_b32 v32, s47
    ds_write_b32 v33, v32
    s_add_u32 s39, s39, 1
    s_cmp_ge_u32 s47, 11
    s_cbranch_scc1 .ere_k3_kernel_112
    s_cmp_ge_u32 s39, 200000
    s_cbranch_scc1 .ere_k3_kernel_112
    s_sleep 2
    s_branch .er_k3_kernel_110
.erl_k3_kernel_111:
    ds_read_b32 v32, v33
    s_waitcnt lgkmcnt(0)
    v_readfirstlane_b32 s47, v32
    s_add_u32 s39, s39, 1
    s_cmp_ge_u32 s47, 11
    s_cbranch_scc1 .ere_k3_kernel_112
    s_cmp_ge_u32 s39, 1600000
    s_cbranch_scc1 .ere_k3_kernel_112
    s_sleep 2
    s_branch .erl_k3_kernel_111
.ere_k3_kernel_112:
    s_add_u32 m0, s21, 122880
    s_nop 0
    global_load_lds_dwordx4 v1, s[4:5] sc1
    global_load_lds_dwordx4 v1, s[4:5] offset:1024 sc1
    s_add_u32 s4, s4, 4096
    s_addc_u32 s5, s5, 0
    s_add_u32 m0, s21, 8192
    s_nop 0
    global_load_lds_dwordx4 v1, s[6:7]
    global_load_lds_dwordx4 v1, s[6:7] offset:1024
    s_add_u32 s6, s6, 8192
    s_addc_u32 s7, s7, 0
    s_waitcnt vmcnt(14)
    s_barrier
    s_cmp_ge_u32 s47, 11
    s_cbranch_scc1 .ere_k3_kernel_115
    s_mov_b32 s39, 0
    v_mov_b32 v33, 163716
    s_cmp_lg_u32 s24, 0
    s_cbranch_scc1 .erl_k3_kernel_114
.er_k3_kernel_113:
    global_load_dword v32, v34, s[12:13] sc1
    s_waitcnt vmcnt(0)
    v_cmp_gt_u32 vcc, 1, v32
    s_nop 3
    s_or_b32 s38, vcc_lo, 0x10000
    s_ff1_i32_b32 s47, s38
    v_mov_b32 v32, s47
    ds_write_b32 v33, v32
    s_add_u32 s39, s39, 1
    s_cmp_ge_u32 s47, 11
    s_cbranch_scc1 .ere_k3_kernel_115
    s_cmp_ge_u32 s39, 200000
    s_cbranch_scc1 .ere_k3_kernel_115
    s_sleep 2
    s_branch .er_k3_kernel_113
.erl_k3_kernel_114:
    ds_read_b32 v32, v33
    s_waitcnt lgkmcnt(0)
    v_readfirstlane_b32 s47, v32
    s_add_u32 s39, s39, 1
    s_cmp_ge_u32 s47, 11
    s_cbranch_scc1 .ere_k3_kernel_115
    s_cmp_ge_u32 s39, 1600000
    s_cbranch_scc1 .ere_k3_kernel_115
    s_sleep 2
    s_branch .erl_k3_kernel_114
.ere_k3_kernel_115:
    s_add_u32 m0, s21, 81920
    s_nop 0
    global_load_lds_dwordx4 v1, s[4:5] sc1
    global_load_lds_dwordx4 v1, s[4:5] offset:1024 sc1
    s_add_u32 s4, s4, 4096
    s_addc_u32 s5, s5, 0
    s_add_u32 m0, s21, 16384
    s_nop 0
    global_load_lds_dwordx4 v1, s[6:7]
    global_load_lds_dwordx4 v1, s[6:7] offset:1024
    s_add_u32 s6, s6, 8192
    s_addc_u32 s7, s7, 0
    s_waitcnt vmcnt(14)
    s_barrier
    s_cmp_ge_u32 s47, 12
    s_cbranch_scc1 .ere_k3_kernel_118
    s_mov_b32 s39, 0
    v_mov_b32 v33, 163716
    s_cmp_lg_u32 s24, 0
    s_cbranch_scc1 .erl_k3_kernel_117
.er_k3_kernel_116:
    global_load_dword v32, v34, s[12:13] sc1
    s_waitcnt vmcnt(0)
    v_cmp_gt_u32 vcc, 1, v32
    s_nop 3
    s_or_b32 s38, vcc_lo, 0x10000
    s_ff1_i32_b32 s47, s38
    v_mov_b32 v32, s47
    ds_write_b32 v33, v32
    s_add_u32 s39, s39, 1
    s_cmp_ge_u32 s47, 12
    s_cbranch_scc1 .ere_k3_kernel_118
    s_cmp_ge_u32 s39, 200000
    s_cbranch_scc1 .ere_k3_kernel_118
    s_sleep 2
    s_branch .er_k3_kernel_116
.erl_k3_kernel_117:
    ds_read_b32 v32, v33
    s_waitcnt lgkmcnt(0)
    v_readfirstlane_b32 s47, v32
    s_add_u32 s39, s39, 1
    s_cmp_ge_u32 s47, 12
    s_cbranch_scc1 .ere_k3_kernel_118
    s_cmp_ge_u32 s39, 1600000
    s_cbranch_scc1 .ere_k3_kernel_118
    s_sleep 2
    s_branch .erl_k3_kernel_117
.ere_k3_kernel_118:
    s_add_u32 m0, s21, 90112
    s_nop 0
    global_load_lds_dwordx4 v1, s[4:5] sc1
    global_load_lds_dwordx4 v1, s[4:5] offset:1024 sc1
    s_add_u32 s4, s4, 4096
    s_addc_u32 s5, s5, 0
    s_add_u32 m0, s21, 24576
    s_nop 0
    global_load_lds_dwordx4 v1, s[6:7]
    global_load_lds_dwordx4 v1, s[6:7] offset:1024
    s_add_u32 s6, s6, 8192
    s_addc_u32 s7, s7, 0
    s_waitcnt vmcnt(14)
    s_barrier
    s_cmp_ge_u32 s47, 12
    s_cbranch_scc1 .ere_k3_kernel_121
    s_mov_b32 s39, 0
    v_mov_b32 v33, 163716
    s_cmp_lg_u32 s24, 0
    s_cbranch_scc1 .erl_k3_kernel_120
.er_k3_kernel_119:
    global_load_dword v32, v34, s[12:13] sc1
    s_waitcnt vmcnt(0)
    v_cmp_gt_u32 vcc, 1, v32
    s_nop 3
    s_or_b32 s38, vcc_lo, 0x10000
    s_ff1_i32_b32 s47, s38
    v_mov_b32 v32, s47
    ds_write_b32 v33, v32
    s_add_u32 s39, s39, 1
    s_cmp_ge_u32 s47, 12
    s_cbranch_scc1 .ere_k3_kernel_121
    s_cmp_ge_u32 s39, 200000
    s_cbranch_scc1 .ere_k3_kernel_121
    s_sleep 2
    s_branch .er_k3_kernel_119
.erl_k3_kernel_120:
    ds_read_b32 v32, v33
    s_waitcnt lgkmcnt(0)
    v_readfirstlane_b32 s47, v32
    s_add_u32 s39, s39, 1
    s_cmp_ge_u32 s47, 12
    s_cbranch_scc1 .ere_k3_kernel_121
    s_cmp_ge_u32 s39, 1600000
    s_cbranch_scc1 .ere_k3_kernel_121
    s_sleep 2
    s_branch .erl_k3_kernel_120
.ere_k3_kernel_121:
    s_add_u32 m0, s21, 98304
    s_nop 0
    global_load_lds_dwordx4 v1, s[4:5] sc1
    global_load_lds_dwordx4 v1, s[4:5] offset:1024 sc1
    s_add_u32 s4, s4, 4096
    s_addc_u32 s5, s5, 0
    s_add_u32 m0, s21, 32768
    s_nop 0
    global_load_lds_dwordx4 v1, s[6:7]
    global_load_lds_dwordx4 v1, s[6:7] offset:1024
    s_add_u32 s6, s6, 8192
    s_addc_u32 s7, s7, 0
    s_waitcnt vmcnt(14)
    s_barrier
    s_cmp_ge_u32 s47, 13
    s_cbranch_scc1 .ere_k3_kernel_124
    s_mov_b32 s39, 0
    v_mov_b32 v33, 163716
    s_cmp_lg_u32 s24, 0
    s_cbranch_scc1 .erl_k3_kernel_123
.er_k3_kernel_122:
    global_load_dword v32, v34, s[12:13] sc1
    s_waitcnt vmcnt(0)
    v_cmp_gt_u32 vcc, 1, v32
    s_nop 3
    s_or_b32 s38, vcc_lo, 0x10000
    s_ff1_i32_b32 s47, s38
    v_mov_b32 v32, s47
    ds_write_b32 v33, v32
    s_add_u32 s39, s39, 1
    s_cmp_ge_u32 s47, 13
    s_cbranch_scc1 .ere_k3_kernel_124
    s_cmp_ge_u32 s39, 200000
    s_cbranch_scc1 .ere_k3_kernel_124
    s_sleep 2
    s_branch .er_k3_kernel_122
.erl_k3_kernel_123:
    ds_read_b32 v32, v33
    s_waitcnt lgkmcnt(0)
    v_readfirstlane_b32 s47, v32
    s_add_u32 s39, s39, 1
    s_cmp_ge_u32 s47, 13
    s_cbranch_scc1 .ere_k3_kernel_124
    s_cmp_ge_u32 s39, 1600000
    s_cbranch_scc1 .ere_k3_kernel_124
    s_sleep 2
    s_branch .erl_k3_kernel_123
.ere_k3_kernel_124:
    s_add_u32 m0, s21, 106496
    s_nop 0
    global_load_lds_dwordx4 v1, s[4:5] sc1
    global_load_lds_dwordx4 v1, s[4:5] offset:1024 sc1
    s_add_u32 s4, s4, 4096
    s_addc_u32 s5, s5, 0
    s_add_u32 m0, s21, 40960
    s_nop 0
    global_load_lds_dwordx4 v1, s[6:7]
    global_load_lds_dwordx4 v1, s[6:7] offset:1024
    s_add_u32 s6, s6, 8192
    s_addc_u32 s7, s7, 0
    s_waitcnt vmcnt(14)
    s_barrier
    s_cmp_ge_u32 s47, 14
    s_cbranch_scc1 .ere_k3_kernel_127
    s_mov_b32 s39, 0
    v_mov_b32 v33, 163716
    s_cmp_lg_u32 s24, 0
    s_cbranch_scc1 .erl_k3_kernel_126
.er_k3_kernel_125:
    global_load_dword v32, v34, s[12:13] sc1
    s_waitcnt vmcnt(0)
    v_cmp_gt_u32 vcc, 1, v32
    s_nop 3
    s_or_b32 s38, vcc_lo, 0x10000
    s_ff1_i32_b32 s47, s38
    v_mov_b32 v32, s47
    ds_write_b32 v33, v32
    s_add_u32 s39, s39, 1
    s_cmp_ge_u32 s47, 14
    s_cbranch_scc1 .ere_k3_kernel_127
    s_cmp_ge_u32 s39, 200000
    s_cbranch_scc1 .ere_k3_kernel_127
    s_sleep 2
    s_branch .er_k3_kernel_125
.erl_k3_kernel_126:
    ds_read_b32 v32, v33
    s_waitcnt lgkmcnt(0)
    v_readfirstlane_b32 s47, v32
    s_add_u32 s39, s39, 1
    s_cmp_ge_u32 s47, 14
    s_cbranch_scc1 .ere_k3_kernel_127
    s_cmp_ge_u32 s39, 1600000
    s_cbranch_scc1 .ere_k3_kernel_127
    s_sleep 2
    s_branch .erl_k3_kernel_126
.ere_k3_kernel_127:
    s_add_u32 m0, s21, 114688
    s_nop 0
    global_load_lds_dwordx4 v1, s[4:5] sc1
    global_load_lds_dwordx4 v1, s[4:5] offset:1024 sc1
    s_add_u32 s4, s4, 4096
    s_addc_u32 s5, s5, 0
    s_add_u32 m0, s21, 49152
    s_nop 0
    global_load_lds_dwordx4 v1, s[6:7]
    global_load_lds_dwordx4 v1, s[6:7] offset:1024
    s_add_u32 s6, s6, 8192
    s_addc_u32 s7, s7, 0
    s_waitcnt vmcnt(14)
    s_barrier
    s_cmp_ge_u32 s47, 14
    s_cbranch_scc1 .ere_k3_kernel_130
    s_mov_b32 s39, 0
    v_mov_b32 v33, 163716
    s_cmp_lg_u32 s24, 0
    s_cbranch_scc1 .erl_k3_kernel_129
.er_k3_kernel_128:
    global_load_dword v32, v34, s[12:13] sc1
    s_waitcnt vmcnt(0)
    v_cmp_gt_u32 vcc, 1, v32
    s_nop 3
    s_or_b32 s38, vcc_lo, 0x10000
    s_ff1_i32_b32 s47, s38
    v_mov_b32 v32, s47
    ds_write_b32 v33, v32
    s_add_u32 s39, s39, 1
    s_cmp_ge_u32 s47, 14
    s_cbranch_scc1 .ere_k3_kernel_130
    s_cmp_ge_u32 s39, 200000
    s_cbranch_scc1 .ere_k3_kernel_130
    s_sleep 2
    s_branch .er_k3_kernel_128
.erl_k3_kernel_129:
    ds_read_b32 v32, v33
    s_waitcnt lgkmcnt(0)
    v_readfirstlane_b32 s47, v32
    s_add_u32 s39, s39, 1
    s_cmp_ge_u32 s47, 14
    s_cbranch_scc1 .ere_k3_kernel_130
    s_cmp_ge_u32 s39, 1600000
    s_cbranch_scc1 .ere_k3_kernel_130
    s_sleep 2
    s_branch .erl_k3_kernel_129
.ere_k3_kernel_130:
    s_add_u32 m0, s21, 122880
    s_nop 0
    global_load_lds_dwordx4 v1, s[4:5] sc1
    global_load_lds_dwordx4 v1, s[4:5] offset:1024 sc1
    s_add_u32 s4, s4, 4096
    s_addc_u32 s5, s5, 0
    s_add_u32 m0, s21, 57344
    s_nop 0
    global_load_lds_dwordx4 v1, s[6:7]
    global_load_lds_dwordx4 v1, s[6:7] offset:1024
    s_add_u32 s6, s6, 8192
    s_addc_u32 s7, s7, 0
    s_waitcnt vmcnt(14)
    s_barrier
    s_cmp_ge_u32 s47, 15
    s_cbranch_scc1 .ere_k3_kernel_133
    s_mov_b32 s39, 0
    v_mov_b32 v33, 163716
    s_cmp_lg_u32 s24, 0
    s_cbranch_scc1 .erl_k3_kernel_132
.er_k3_kernel_131:
    global_load_dword v32, v34, s[12:13] sc1
    s_waitcnt vmcnt(0)
    v_cmp_gt_u32 vcc, 1, v32
    s_nop 3
    s_or_b32 s38, vcc_lo, 0x10000
    s_ff1_i32_b32 s47, s38
    v_mov_b32 v32, s47
    ds_write_b32 v33, v32
    s_add_u32 s39, s39, 1
    s_cmp_ge_u32 s47, 15
    s_cbranch_scc1 .ere_k3_kernel_133
    s_cmp_ge_u32 s39, 200000
    s_cbranch_scc1 .ere_k3_kernel_133
    s_sleep 2
    s_branch .er_k3_kernel_131
.erl_k3_kernel_132:
    ds_read_b32 v32, v33
    s_waitcnt lgkmcnt(0)
    v_readfirstlane_b32 s47, v32
    s_add_u32 s39, s39, 1
    s_cmp_ge_u32 s47, 15
    s_cbranch_scc1 .ere_k3_kernel_133
    s_cmp_ge_u32 s39, 1600000
    s_cbranch_scc1 .ere_k3_kernel_133
    s_sleep 2
    s_branch .erl_k3_kernel_132
.ere_k3_kernel_133:
    s_add_u32 m0, s21, 81920
    s_nop 0
    global_load_lds_dwordx4 v1, s[4:5] sc1
    global_load_lds_dwordx4 v1, s[4:5] offset:1024 sc1
    s_add_u32 s4, s4, 4096
    s_addc_u32 s5, s5, 0
    s_waitcnt vmcnt(12)
    s_barrier
    s_cmp_ge_u32 s47, 15
    s_cbranch_scc1 .ere_k3_kernel_136
    s_mov_b32 s39, 0
    v_mov_b32 v33, 163716
    s_cmp_lg_u32 s24, 0
    s_cbranch_scc1 .erl_k3_kernel_135
.er_k3_kernel_134:
    global_load_dword v32, v34, s[12:13] sc1
    s_waitcnt vmcnt(0)
    v_cmp_gt_u32 vcc, 1, v32
    s_nop 3
    s_or_b32 s38, vcc_lo, 0x10000
    s_ff1_i32_b32 s47, s38
    v_mov_b32 v32, s47
    ds_write_b32 v33, v32
    s_add_u32 s39, s39, 1
    s_cmp_ge_u32 s47, 15
    s_cbranch_scc1 .ere_k3_kernel_136
    s_cmp_ge_u32 s39, 200000
    s_cbranch_scc1 .ere_k3_kernel_136
    s_sleep 2
    s_branch .er_k3_kernel_134
.erl_k3_kernel_135:
    ds_read_b32 v32, v33
    s_waitcnt lgkmcnt(0)
    v_readfirstlane_b32 s47, v32
    s_add_u32 s39, s39, 1
    s_cmp_ge_u32 s47, 15
    s_cbranch_scc1 .ere_k3_kernel_136
    s_cmp_ge_u32 s39, 1600000
    s_cbranch_scc1 .ere_k3_kernel_136
    s_sleep 2
    s_branch .erl_k3_kernel_135
.ere_k3_kernel_136:
    s_add_u32 m0, s21, 90112
    s_nop 0
    global_load_lds_dwordx4 v1, s[4:5] sc1
    global_load_lds_dwordx4 v1, s[4:5] offset:1024 sc1
    s_add_u32 s4, s4, 4096
    s_addc_u32 s5, s5, 0
    s_waitcnt vmcnt(10)
    s_barrier
    s_cmp_ge_u32 s47, 16
    s_cbranch_scc1 .ere_k3_kernel_139
    s_mov_b32 s39, 0
    v_mov_b32 v33, 163716
    s_cmp_lg_u32 s24, 0
    s_cbranch_scc1 .erl_k3_kernel_138
.er_k3_kernel_137:
    global_load_dword v32, v34, s[12:13] sc1
    s_waitcnt vmcnt(0)
    v_cmp_gt_u32 vcc, 1, v32
    s_nop 3
    s_or_b32 s38, vcc_lo, 0x10000
    s_ff1_i32_b32 s47, s38
    v_mov_b32 v32, s47
    ds_write_b32 v33, v32
    s_add_u32 s39, s39, 1
    s_cmp_ge_u32 s47, 16
    s_cbranch_scc1 .ere_k3_kernel_139
    s_cmp_ge_u32 s39, 200000
    s_cbranch_scc1 .ere_k3_kernel_139
    s_sleep 2
    s_branch .er_k3_kernel_137
.erl_k3_kernel_138:
    ds_read_b32 v32, v33
    s_waitcnt lgkmcnt(0)
    v_readfirstlane_b32 s47, v32
    s_add_u32 s39, s39, 1
    s_cmp_ge_u32 s47, 16
    s_cbranch_scc1 .ere_k3_kernel_139
    s_cmp_ge_u32 s39, 1600000
    s_cbranch_scc1 .ere_k3_kernel_139
    s_sleep 2
    s_branch .erl_k3_kernel_138
.ere_k3_kernel_139:
    s_add_u32 m0, s21, 98304
    s_nop 0
    global_load_lds_dwordx4 v1, s[4:5] sc1
    global_load_lds_dwordx4 v1, s[4:5] offset:1024 sc1
    s_add_u32 s4, s4, 4096
    s_addc_u32 s5, s5, 0
    s_waitcnt vmcnt(8)
    s_barrier
    s_cmp_ge_u32 s47, 16
    s_cbranch_scc1 .ere_k3_kernel_142
    s_mov_b32 s39, 0
    v_mov_b32 v33, 163716
    s_cmp_lg_u32 s24, 0
    s_cbranch_scc1 .erl_k3_kernel_141
.er_k3_kernel_140:
    global_load_dword v32, v34, s[12:13] sc1
    s_waitcnt vmcnt(0)
    v_cmp_gt_u32 vcc, 1, v32
    s_nop 3
    s_or_b32 s38, vcc_lo, 0x10000
    s_ff1_i32_b32 s47, s38
    v_mov_b32 v32, s47
    ds_write_b32 v33, v32
    s_add_u32 s39, s39, 1
    s_cmp_ge_u32 s47, 16
    s_cbranch_scc1 .ere_k3_kernel_142
    s_cmp_ge_u32 s39, 200000
    s_cbranch_scc1 .ere_k3_kernel_142
    s_sleep 2
    s_branch .er_k3_kernel_140
.erl_k3_kernel_141:
    ds_read_b32 v32, v33
    s_waitcnt lgkmcnt(0)
    v_readfirstlane_b32 s47, v32
    s_add_u32 s39, s39, 1
    s_cmp_ge_u32 s47, 16
    s_cbranch_scc1 .ere_k3_kernel_142
    s_cmp_ge_u32 s39, 1600000
    s_cbranch_scc1 .ere_k3_kernel_142
    s_sleep 2
    s_branch .erl_k3_kernel_141
.ere_k3_kernel_142:
    s_add_u32 m0, s21, 106496
    s_nop 0
    global_load_lds_dwordx4 v1, s[4:5] sc1
    global_load_lds_dwordx4 v1, s[4:5] offset:1024 sc1
    s_add_u32 s4, s4, 4096
    s_addc_u32 s5, s5, 0
    s_waitcnt vmcnt(6)
    s_barrier
    s_waitcnt vmcnt(4)
    s_barrier
    s_waitcnt vmcnt(2)
    s_barrier
    s_waitcnt vmcnt(0)
    s_barrier
.L_k3_end:
    s_endpgm
code_end_marker:
.section .rodata,"a"
.p2align 6
.amdhsa_kernel k1_kernel
  .amdhsa_next_free_vgpr 136
  .amdhsa_next_free_sgpr 102
  .amdhsa_accum_offset 136
  .amdhsa_group_segment_fixed_size 0
  .amdhsa_kernarg_size 96
  .amdhsa_user_sgpr_count 2
  .amdhsa_user_sgpr_kernarg_segment_ptr 1
  .amdhsa_system_sgpr_workgroup_id_x 1
.end_amdhsa_kernel
.p2align 6
.amdhsa_kernel k3_kernel
  .amdhsa_next_free_vgpr 200
  .amdhsa_next_free_sgpr 102
  .amdhsa_accum_offset 200
  .amdhsa_group_segment_fixed_size 0
  .amdhsa_kernarg_size 96
  .amdhsa_user_sgpr_count 2
  .amdhsa_user_sgpr_kernarg_segment_ptr 1
  .amdhsa_system_sgpr_workgroup_id_x 1
.end_amdhsa_kernel
```
